```python
import torch

def _softmax(x, axis=-1):
    return torch.softmax(x, dim=axis)
def _gelu(x):
    return torch.nn.functional.gelu(x, approximate="tanh")
def _silu(x):
    return torch.nn.functional.silu(x)
def _sigmoid(x):
    return torch.sigmoid(x)
def _layernorm(x, axis=-1, eps=1e-5):
    m = x.mean(dim=axis, keepdim=True)
    v = x.var(dim=axis, keepdim=True, unbiased=False)
    return (x - m) / torch.sqrt(v + eps)
def _scatter_add(tgt, idx, src, axis=0):
    return tgt.clone().index_add_(axis, idx, src)
def _segment_sum(src, seg, n):
    out = torch.zeros((n,) + src.shape[1:], dtype=src.dtype)
    return out.index_add_(0, seg, src)
def _pad(x, pw):
    flat = tuple(v for pair in reversed(pw) for v in pair)
    return torch.nn.functional.pad(x, flat)

kernel_name = 'sequential_preLN__linear_kernel_hedgehog__dense_activation_gelu__prompt'

def setup_inputs():

    _w = (lambda a: (lambda t: t.to(torch.bfloat16) if t.is_floating_point() else t)(torch.as_tensor(a)))
    def _A_setup():
        B, S, D, H = 1, 2048, 448, 16
        Dh = D // H
        return {
            "x": _w((lambda *s: torch.randn(*s, dtype=torch.bfloat16) * 0.05)(B, S, D)),
            "wqkv": _w((lambda *s: torch.randn(*s, dtype=torch.bfloat16) * 0.2)(D, 3 * D)),
            "w_phi": _w((lambda *s: torch.randn(*s, dtype=torch.bfloat16) * 0.2)(H, Dh, Dh) * (Dh ** -0.5)),
            "wo": _w((lambda *s: torch.randn(*s, dtype=torch.bfloat16) * 0.05)(D, D)),
        }
    _A_in = _A_setup()

    def _B_setup():
        B, S, D, F = 1, 2048, 448, 1792
        return {
            "x": _w((lambda *s: torch.randn(*s, dtype=torch.bfloat16) * 0.05)(B, S, D)),
            "w1": _w((lambda *s: torch.randn(*s, dtype=torch.bfloat16) * 1.6)(D, F) * (D ** -0.5)),
            "b1": _w((lambda *s: torch.randn(*s, dtype=torch.bfloat16) * 0.1)(F) * 0.01),
            "w2": _w((lambda *s: torch.randn(*s, dtype=torch.bfloat16) * 0.1)(F, D) * (F ** -0.5)),
            "b2": _w((lambda *s: torch.randn(*s, dtype=torch.bfloat16) * 0.1)(D) * 0.01),
        }
    _B_in = _B_setup()

    return {
        "A_x": _A_in["x"],
        "A_wqkv": _A_in["wqkv"],
        "A_w_phi": _A_in["w_phi"],
        "A_wo": _A_in["wo"],
        "B_x": _B_in["x"],
        "B_w1": _B_in["w1"],
        "B_b1": _B_in["b1"],
        "B_w2": _B_in["w2"],
        "B_b2": _B_in["b2"],
    }

def reference(A_x, A_wqkv, A_w_phi, A_wo, B_x, B_w1, B_b1, B_w2, B_b2):
    def _A_ref(x, wqkv, w_phi, wo):
        B, S, D = x.shape
        H = 16; Dh = D // H
        qkv = (lambda x, *d: x.permute(*d))((x @ wqkv).reshape(B, S, 3, H, Dh), 2, 0, 3, 1, 4)
        q, k, v = qkv[0], qkv[1], qkv[2]
        pq = torch.einsum("bhsd,hdf->bhsf", q, w_phi)
        pk = torch.einsum("bhsd,hdf->bhsf", k, w_phi)
        phi_q = torch.concatenate([_softmax(pq, axis=-1), _softmax(-pq, axis=-1)], axis=-1)
        phi_k = torch.concatenate([_softmax(pk, axis=-1), _softmax(-pk, axis=-1)], axis=-1)
        kv = torch.einsum("bhsf,bhsd->bhfd", phi_k, v)
        z  = torch.einsum("bhsf->bhf", phi_k)
        num = torch.einsum("bhqf,bhfd->bhqd", phi_q, kv)
        den = torch.einsum("bhqf,bhf->bhq", phi_q, z)[..., None] + 1e-6
        o = num / den
        return (lambda x, *d: x.permute(*d))(o, 0, 2, 1, 3).reshape(B, S, D) @ wo

    def _B_ref(x, w1, b1, w2, b2):
        h = torch.einsum("bsd,df->bsf", x, w1) + b1
        h = _gelu(h)
        return torch.einsum("bsf,fd->bsd", h, w2) + b2

    x = A_x
    h = x + _A_ref(_layernorm(x, axis=-1), A_wqkv, A_w_phi, A_wo)
    h2 = h + _B_ref(_layernorm(h, axis=-1), B_w1, B_b1, B_w2, B_b2)
    return h2
```

```asm
; @launch grid=(256,1,1) block=(256,1,1) lds=163840
.amdgcn_target "amdgcn-amd-amdhsa--gfx950"
.text
.globl sequential_preLN__linear_kernel_hedgehog__dense_activation_gelu__prompt_kernel
.p2align 8
.type sequential_preLN__linear_kernel_hedgehog__dense_activation_gelu__prompt_kernel,@function
sequential_preLN__linear_kernel_hedgehog__dense_activation_gelu__prompt_kernel:
  s_cmp_ge_u32 s2, 256
  s_cbranch_scc1 L_END
  s_load_dwordx16 s[52:67], s[0:1], 0
  s_load_dwordx8 s[68:75], s[0:1], 64
  s_getpc_b64 s[100:101]
L_PC:
  s_sub_u32 s100, s100, L_PC-sequential_preLN__linear_kernel_hedgehog__dense_activation_gelu__prompt_kernel
  s_subb_u32 s101, s101, 0
  s_lshr_b32 s3, s2, 3
  s_lshl_b32 s3, s3, 11
  v_and_b32 v7, 0xc0, v0
  v_lshlrev_b32 v7, 3, v7
  v_and_b32 v8, 7, v0
  v_lshl_add_u32 v7, v8, 6, v7
  v_add_u32 v7, s3, v7
  v_min_u32 v7, L_END-sequential_preLN__linear_kernel_hedgehog__dense_activation_gelu__prompt_kernel, v7
  global_load_dword a9, v7, s[100:101]
  s_memrealtime s[98:99]
  v_and_b32 v1, 63, v0
  v_lshrrev_b32 v7, 6, v0
  v_lshlrev_b32 v2, 4, v1
  v_readfirstlane_b32 s78, v7
  v_lshrrev_b32 v3, 5, v1
  s_and_b32 s81, s2, 7
  s_lshr_b32 s82, s2, 3
  s_lshr_b32 s83, s82, 4
  s_lshl_b32 s76, s81, 1
  s_add_u32 s76, s76, s83
  s_and_b32 s77, s82, 15
  s_add_u32 s81, s76, s77
  s_mul_i32 s82, s81, 37
  s_lshr_b32 s82, s82, 8
  s_mul_i32 s82, s82, 7
  s_sub_u32 s95, s81, s82
  v_lshrrev_b32 v10, 3, v1
  v_and_b32 v11, 7, v1
  v_lshrrev_b32 v12, 1, v10
  v_xor_b32 v13, v11, v12
  v_mul_u32_u24 v10, 896, v10
  v_lshl_add_u32 v8, v13, 4, v10
  v_xor_b32 v13, 4, v13
  v_lshl_add_u32 v9, v13, 4, v10
  v_add_u32 v9, 6144, v9
  v_add_u32 v228, 12288, v8
  v_add_u32 v229, 12288, v9
  v_lshrrev_b32 v11, 2, v1
  v_mul_u32_u24 v11, 2688, v11
  v_and_b32 v12, 3, v1
  v_lshl_add_u32 v255, v12, 4, v11
  s_lshl_b32 s81, s76, 2
  s_add_u32 s81, s81, s78
  s_mul_i32 s85, s81, 28672
  s_mul_i32 s86, s78, 43008
  s_mul_i32 s81, s77, 56
  s_add_u32 s86, s86, s81
  s_and_b32 s81, s77, 1
  s_lshl_b32 s81, s81, 3
  s_sub_u32 s86, s86, s81
  s_lshl_b32 s87, s78, 10
  s_lshl_b32 s92, s78, 12
  s_mov_b32 s3, s95
  s_waitcnt lgkmcnt(0)
  s_mov_b32 s8, s52
  s_mov_b32 s9, s53
  s_mov_b32 s10, 1835008
  s_mov_b32 s11, 0x20000
  s_mov_b32 s12, s54
  s_mov_b32 s13, s55
  s_mov_b32 s14, 1204224
  s_mov_b32 s15, 0x20000
  s_lshl_b32 s5, s3, 7
  s_add_u32 s5, s5, s85
  s_mul_i32 s91, s3, 172032
  s_add_u32 s91, s91, s86
  s_add_u32 s3, s3, 1
  s_cmp_eq_u32 s3, 7
  s_cselect_b32 s3, 0, s3
  s_add_u32 m0, s92, 0
  s_nop 0
  buffer_load_dwordx4 v8, s[8:11], s5 offen offset:0 lds
  buffer_load_dwordx4 v9, s[8:11], s5 offen offset:1024 lds
  buffer_load_dwordx4 v228, s[8:11], s5 offen offset:2048 lds
  buffer_load_dwordx4 v229, s[8:11], s5 offen offset:3072 lds
  s_add_u32 m0, s87, 113792
  s_nop 0
  buffer_load_dwordx4 v255, s[12:15], s91 offen offset:896 lds
  s_add_u32 m0, s87, 141568
  s_nop 0
  buffer_load_dwordx4 v255, s[12:15], s91 offen offset:1792 lds
  s_mov_b32 s40, s72
  s_mov_b32 s41, s73
  s_mov_b32 s42, 256
  s_mov_b32 s43, 0x20000
  s_or_b32 s81, s2, s78
  s_cmp_lg_u32 s81, 0
  s_cbranch_scc1 L_nl_1
  s_and_b32 s98, s98, 0xfffffff0
  s_or_b32 s98, s98, 8
  v_mov_b32 v14, s98
  s_xor_b32 s99, s99, 0x5bd1e995
  v_mov_b32 v15, s99
  v_mov_b32 v13, 0
  s_mov_b64 s[100:101], exec
  s_mov_b64 exec, 1
  buffer_store_dwordx2 v[14:15], v13, s[40:43], 0 offen sc1
  s_mov_b64 exec, s[100:101]
L_nl_1:
  s_lshl_b32 s5, s3, 7
  s_add_u32 s5, s5, s85
  s_mul_i32 s91, s3, 172032
  s_add_u32 s91, s91, s86
  s_add_u32 s3, s3, 1
  s_cmp_eq_u32 s3, 7
  s_cselect_b32 s3, 0, s3
  s_add_u32 m0, s92, 16384
  s_nop 0
  buffer_load_dwordx4 v8, s[8:11], s5 offen offset:0 lds
  buffer_load_dwordx4 v9, s[8:11], s5 offen offset:1024 lds
  buffer_load_dwordx4 v228, s[8:11], s5 offen offset:2048 lds
  buffer_load_dwordx4 v229, s[8:11], s5 offen offset:3072 lds
  s_add_u32 m0, s87, 117888
  s_nop 0
  buffer_load_dwordx4 v255, s[12:15], s91 offen offset:896 lds
  s_add_u32 m0, s87, 145664
  s_nop 0
  buffer_load_dwordx4 v255, s[12:15], s91 offen offset:1792 lds
  s_mov_b32 s16, s56
  s_mov_b32 s17, s57
  s_mov_b32 s18, 25088
  s_mov_b32 s19, 0x20000
  s_mov_b32 s20, s58
  s_mov_b32 s21, s59
  s_mov_b32 s22, 401408
  s_mov_b32 s23, 0x20000
  s_mov_b32 s24, s62
  s_mov_b32 s25, s63
  s_mov_b32 s26, 1605632
  s_mov_b32 s27, 0x20000
  s_mov_b32 s44, s64
  s_mov_b32 s45, s65
  s_mov_b32 s46, 3584
  s_mov_b32 s47, 0x20000
  s_mov_b32 s28, s66
  s_mov_b32 s29, s67
  s_mov_b32 s30, 1605632
  s_mov_b32 s31, 0x20000
  s_mov_b32 s48, s68
  s_mov_b32 s49, s69
  s_mov_b32 s50, 896
  s_mov_b32 s51, 0x20000
  s_mov_b32 s32, s70
  s_mov_b32 s33, s71
  s_mov_b32 s34, 1835008
  s_mov_b32 s35, 0x20000
  s_mov_b32 s36, s74
  s_mov_b32 s37, s75
  s_mov_b32 s38, 18874368
  s_mov_b32 s39, 0x20000
  v_add_u32 v4, -1, v3
  v_not_b32 v7, v4
  v_and_b32 v5, 0xff800000, v7
  v_and_b32 v6, 0x7f800000, v7
  v_and_b32 v7, 31, v1
  v_lshrrev_b32 v11, 1, v7
  v_and_b32 v11, 7, v11
  v_xor_b32 v11, v11, v3
  v_lshlrev_b32 v7, 7, v7
  v_add_u32 v7, s92, v7
  v_xor_b32 v12, 0, v11
  v_lshl_add_u32 v246, v12, 4, v7
  v_xor_b32 v12, 2, v11
  v_lshl_add_u32 v247, v12, 4, v7
  v_xor_b32 v12, 4, v11
  v_lshl_add_u32 v248, v12, 4, v7
  v_xor_b32 v12, 6, v11
  v_lshl_add_u32 v249, v12, 4, v7
  v_bfe_u32 v7, v1, 2, 2
  v_lshl_add_u32 v7, v3, 3, v7
  v_lshlrev_b32 v7, 6, v7
  v_bfe_u32 v11, v1, 4, 1
  v_lshl_add_u32 v7, v11, 5, v7
  v_and_b32 v11, 3, v1
  v_lshl_add_u32 v7, v11, 3, v7
  s_and_b32 s82, s77, 1
  s_lshl_b32 s82, s82, 3
  v_add_u32 v253, s82, v7
  v_add_u32 v250, 114688, v253
  v_add_u32 v251, 143360, v253
  s_and_b32 s82, s78, 1
  s_mul_i32 s82, s82, 28672
  v_add_u32 v252, s82, v250
  v_mov_b32 v208, 0x3f803f80
  v_mov_b32 v209, 0x3f803f80
  v_mov_b32 v210, 0x3f803f80
  v_mov_b32 v211, 0x3f803f80
  v_mov_b32 v220, 0
  v_mov_b32 v221, 0
  v_mov_b32 v222, 0
  v_mov_b32 v223, 0
  v_mov_b32 v224, 0
  v_mov_b32 v225, 0
  v_mov_b32 v226, 0
  v_mov_b32 v227, 0
  v_and_b32 v7, 31, v1
  v_add_u32 v7, 4, v7
  v_lshrrev_b32 v7, 5, v7
  v_sub_u32 v232, 0, v7
  v_and_b32 v7, 31, v1
  v_bfe_u32 v11, v7, 1, 1
  v_lshlrev_b32 v11, 3, v11
  v_bfe_u32 v12, v7, 3, 1
  v_lshl_or_b32 v11, v12, 2, v11
  v_bfe_u32 v12, v7, 2, 1
  v_lshl_or_b32 v11, v12, 1, v11
  v_and_b32 v12, 1, v7
  v_or_b32 v11, v11, v12
  v_xor_b32 v11, v11, v3
  v_lshlrev_b32 v11, 3, v11
  v_lshl_or_b32 v11, v7, 7, v11
  v_add_u32 v11, s92, v11
  v_add_u32 v11, 114688, v11
  v_accvgpr_write_b32 a0, v11
  v_bfe_u32 v11, v7, 1, 3
  v_xor_b32 v11, v11, v3
  v_lshlrev_b32 v11, 3, v11
  v_lshl_or_b32 v11, v7, 6, v11
  s_lshl_b32 s82, s78, 11
  v_add_u32 v11, s82, v11
  v_add_u32 v11, 131072, v11
  v_accvgpr_write_b32 a1, v11
  v_bfe_u32 v7, v1, 2, 2
  v_lshrrev_b32 v11, 1, v7
  v_lshlrev_b32 v11, 3, v11
  v_lshl_or_b32 v11, v3, 2, v11
  v_and_b32 v12, 1, v7
  v_or_b32 v11, v11, v12
  v_bfe_u32 v12, v1, 4, 1
  v_lshlrev_b32 v12, 2, v12
  v_and_b32 v13, 3, v1
  v_or_b32 v12, v12, v13
  v_xor_b32 v11, v11, v12
  v_lshlrev_b32 v11, 3, v11
  v_lshl_add_u32 v13, v3, 3, v7
  v_lshl_or_b32 v11, v13, 7, v11
  s_and_b32 s82, s78, 1
  s_lshl_b32 s82, s82, 6
  v_xor_b32 v11, s82, v11
  v_add_u32 v14, 114688, v11
  v_accvgpr_write_b32 a2, v14
  v_xor_b32 v14, 16, v11
  v_add_u32 v14, 114688, v14
  v_accvgpr_write_b32 a3, v14
  v_lshrrev_b32 v11, 1, v7
  v_lshl_or_b32 v11, v3, 2, v11
  v_xor_b32 v11, v11, v12
  v_lshlrev_b32 v11, 3, v11
  v_lshl_or_b32 v11, v13, 6, v11
  v_add_u32 v14, 131072, v11
  v_accvgpr_write_b32 a4, v14
  v_xor_b32 v11, 16, v11
  v_add_u32 v11, 131072, v11
  v_accvgpr_write_b32 a5, v11
  s_waitcnt vmcnt(6)
  s_barrier
  ds_read_b128 v[16:19], v246 offset:0
  ds_read_b64_tr_b16 v[192:193], v250 offset:0
  ds_read_b64_tr_b16 v[194:195], v250 offset:256
  ds_read_b64_tr_b16 v[196:197], v251 offset:0
  ds_read_b64_tr_b16 v[198:199], v251 offset:256
  ds_read_b64_tr_b16 v[176:177], v252 offset:0
  ds_read_b64_tr_b16 v[178:179], v252 offset:256
  ds_read_b128 v[20:23], v247 offset:0
  ds_read_b64_tr_b16 v[200:201], v250 offset:1024
  ds_read_b64_tr_b16 v[202:203], v250 offset:1280
  ds_read_b64_tr_b16 v[204:205], v251 offset:1024
  ds_read_b64_tr_b16 v[206:207], v251 offset:1280
  ds_read_b64_tr_b16 v[180:181], v252 offset:1024
  ds_read_b64_tr_b16 v[182:183], v252 offset:1280
  s_lshl_b32 s5, s3, 7
  s_add_u32 s5, s5, s85
  s_mul_i32 s91, s3, 172032
  s_add_u32 s91, s91, s86
  s_add_u32 s3, s3, 1
  s_cmp_eq_u32 s3, 7
  s_cselect_b32 s3, 0, s3
  s_add_u32 m0, s92, 32768
  s_nop 0
  buffer_load_dwordx4 v8, s[8:11], s5 offen offset:0 lds
  s_waitcnt lgkmcnt(7)
  v_bfi_b32 v192, v232, v208, v192
  v_bfi_b32 v193, v232, v208, v193
  v_bfi_b32 v194, v232, v208, v194
  v_bfi_b32 v195, v232, v208, v195
  v_mfma_f32_32x32x16_bf16 v[160:175], v[196:199], v[16:19], 0
  v_mfma_f32_32x32x16_bf16 v[144:159], v[176:179], v[208:211], 0
  v_mfma_f32_32x32x16_bf16 v[128:143], v[192:195], v[16:19], 0
  ds_read_b128 v[24:27], v248 offset:0
  ds_read_b64_tr_b16 v[192:193], v250 offset:2048
  ds_read_b64_tr_b16 v[194:195], v250 offset:2304
  ds_read_b64_tr_b16 v[196:197], v251 offset:2048
  ds_read_b64_tr_b16 v[198:199], v251 offset:2304
  ds_read_b64_tr_b16 v[176:177], v252 offset:2048
  ds_read_b64_tr_b16 v[178:179], v252 offset:2304
  buffer_load_dwordx4 v9, s[8:11], s5 offen offset:1024 lds
  buffer_load_dwordx4 v228, s[8:11], s5 offen offset:2048 lds
  s_waitcnt lgkmcnt(7)
  v_bfi_b32 v200, v232, v208, v200
  v_bfi_b32 v201, v232, v208, v201
  v_bfi_b32 v202, v232, v208, v202
  v_bfi_b32 v203, v232, v208, v203
  v_mfma_f32_32x32x16_bf16 v[160:175], v[204:207], v[20:23], v[160:175]
  v_mfma_f32_32x32x16_bf16 v[144:159], v[180:183], v[208:211], v[144:159]
  v_mfma_f32_32x32x16_bf16 v[128:143], v[200:203], v[20:23], v[128:143]
  ds_read_b128 v[28:31], v249 offset:0
  ds_read_b64_tr_b16 v[200:201], v250 offset:3072
  ds_read_b64_tr_b16 v[202:203], v250 offset:3328
  ds_read_b64_tr_b16 v[204:205], v251 offset:3072
  ds_read_b64_tr_b16 v[206:207], v251 offset:3328
  ds_read_b64_tr_b16 v[180:181], v252 offset:3072
  ds_read_b64_tr_b16 v[182:183], v252 offset:3328
  buffer_load_dwordx4 v229, s[8:11], s5 offen offset:3072 lds
  s_waitcnt lgkmcnt(7)
  v_bfi_b32 v192, v232, v208, v192
  v_bfi_b32 v193, v232, v208, v193
  v_bfi_b32 v194, v232, v208, v194
  v_bfi_b32 v195, v232, v208, v195
  v_mfma_f32_32x32x16_bf16 v[160:175], v[196:199], v[24:27], v[160:175]
  v_mfma_f32_32x32x16_bf16 v[144:159], v[176:179], v[208:211], v[144:159]
  v_mfma_f32_32x32x16_bf16 v[128:143], v[192:195], v[24:27], v[128:143]
  s_add_u32 m0, s87, 121984
  s_nop 0
  buffer_load_dwordx4 v255, s[12:15], s91 offen offset:896 lds
  s_add_u32 m0, s87, 149760
  s_nop 0
  buffer_load_dwordx4 v255, s[12:15], s91 offen offset:1792 lds
  s_waitcnt lgkmcnt(0)
  v_bfi_b32 v200, v232, v208, v200
  v_bfi_b32 v201, v232, v208, v201
  v_bfi_b32 v202, v232, v208, v202
  v_bfi_b32 v203, v232, v208, v203
  v_mfma_f32_32x32x16_bf16 v[160:175], v[204:207], v[28:31], v[160:175]
  v_mfma_f32_32x32x16_bf16 v[144:159], v[180:183], v[208:211], v[144:159]
  v_mfma_f32_32x32x16_bf16 v[128:143], v[200:203], v[28:31], v[128:143]
  s_waitcnt vmcnt(6)
  s_barrier
  ds_read_b128 v[32:35], v246 offset:16384
  ds_read_b64_tr_b16 v[192:193], v250 offset:4096
  ds_read_b64_tr_b16 v[194:195], v250 offset:4352
  ds_read_b64_tr_b16 v[196:197], v251 offset:4096
  ds_read_b64_tr_b16 v[198:199], v251 offset:4352
  ds_read_b64_tr_b16 v[176:177], v252 offset:4096
  ds_read_b64_tr_b16 v[178:179], v252 offset:4352
  ds_read_b128 v[36:39], v247 offset:16384
  ds_read_b64_tr_b16 v[200:201], v250 offset:5120
  ds_read_b64_tr_b16 v[202:203], v250 offset:5376
  ds_read_b64_tr_b16 v[204:205], v251 offset:5120
  ds_read_b64_tr_b16 v[206:207], v251 offset:5376
  ds_read_b64_tr_b16 v[180:181], v252 offset:5120
  ds_read_b64_tr_b16 v[182:183], v252 offset:5376
  s_lshl_b32 s5, s3, 7
  s_add_u32 s5, s5, s85
  s_mul_i32 s91, s3, 172032
  s_add_u32 s91, s91, s86
  s_add_u32 s3, s3, 1
  s_cmp_eq_u32 s3, 7
  s_cselect_b32 s3, 0, s3
  s_add_u32 m0, s92, 49152
  s_nop 0
  buffer_load_dwordx4 v8, s[8:11], s5 offen offset:0 lds
  v_dot2c_f32_bf16 v224, v16, v16
  v_dot2c_f32_bf16 v225, v17, v17
  v_dot2c_f32_bf16 v226, v18, v18
  v_dot2c_f32_bf16 v227, v19, v19
  v_dot2c_f32_bf16 v224, v20, v20
  v_dot2c_f32_bf16 v225, v21, v21
  v_dot2c_f32_bf16 v226, v22, v22
  v_dot2c_f32_bf16 v227, v23, v23
  v_dot2c_f32_bf16 v224, v24, v24
  v_dot2c_f32_bf16 v225, v25, v25
  v_dot2c_f32_bf16 v226, v26, v26
  v_dot2c_f32_bf16 v227, v27, v27
  v_dot2c_f32_bf16 v224, v28, v28
  v_dot2c_f32_bf16 v225, v29, v29
  v_dot2c_f32_bf16 v226, v30, v30
  v_dot2c_f32_bf16 v227, v31, v31
  s_waitcnt lgkmcnt(7)
  v_bfi_b32 v192, v232, v208, v192
  v_bfi_b32 v193, v232, v208, v193
  v_bfi_b32 v194, v232, v208, v194
  v_bfi_b32 v195, v232, v208, v195
  v_mfma_f32_32x32x16_bf16 v[160:175], v[196:199], v[32:35], v[160:175]
  v_mfma_f32_32x32x16_bf16 v[144:159], v[176:179], v[208:211], v[144:159]
  v_mfma_f32_32x32x16_bf16 v[128:143], v[192:195], v[32:35], v[128:143]
  ds_read_b128 v[40:43], v248 offset:16384
  ds_read_b64_tr_b16 v[192:193], v250 offset:6144
  ds_read_b64_tr_b16 v[194:195], v250 offset:6400
  ds_read_b64_tr_b16 v[196:197], v251 offset:6144
  ds_read_b64_tr_b16 v[198:199], v251 offset:6400
  ds_read_b64_tr_b16 v[176:177], v252 offset:6144
  ds_read_b64_tr_b16 v[178:179], v252 offset:6400
  buffer_load_dwordx4 v9, s[8:11], s5 offen offset:1024 lds
  buffer_load_dwordx4 v228, s[8:11], s5 offen offset:2048 lds
  s_waitcnt lgkmcnt(7)
  v_bfi_b32 v200, v232, v208, v200
  v_bfi_b32 v201, v232, v208, v201
  v_bfi_b32 v202, v232, v208, v202
  v_bfi_b32 v203, v232, v208, v203
  v_mfma_f32_32x32x16_bf16 v[160:175], v[204:207], v[36:39], v[160:175]
  v_mfma_f32_32x32x16_bf16 v[144:159], v[180:183], v[208:211], v[144:159]
  v_mfma_f32_32x32x16_bf16 v[128:143], v[200:203], v[36:39], v[128:143]
  ds_read_b128 v[44:47], v249 offset:16384
  ds_read_b64_tr_b16 v[200:201], v250 offset:7168
  ds_read_b64_tr_b16 v[202:203], v250 offset:7424
  ds_read_b64_tr_b16 v[204:205], v251 offset:7168
  ds_read_b64_tr_b16 v[206:207], v251 offset:7424
  ds_read_b64_tr_b16 v[180:181], v252 offset:7168
  ds_read_b64_tr_b16 v[182:183], v252 offset:7424
  buffer_load_dwordx4 v229, s[8:11], s5 offen offset:3072 lds
  s_waitcnt lgkmcnt(7)
  v_bfi_b32 v192, v232, v208, v192
  v_bfi_b32 v193, v232, v208, v193
  v_bfi_b32 v194, v232, v208, v194
  v_bfi_b32 v195, v232, v208, v195
  v_mfma_f32_32x32x16_bf16 v[160:175], v[196:199], v[40:43], v[160:175]
  v_mfma_f32_32x32x16_bf16 v[144:159], v[176:179], v[208:211], v[144:159]
  v_mfma_f32_32x32x16_bf16 v[128:143], v[192:195], v[40:43], v[128:143]
  s_add_u32 m0, s87, 126080
  s_nop 0
  buffer_load_dwordx4 v255, s[12:15], s91 offen offset:896 lds
  s_add_u32 m0, s87, 153856
  s_nop 0
  buffer_load_dwordx4 v255, s[12:15], s91 offen offset:1792 lds
  s_waitcnt lgkmcnt(0)
  v_bfi_b32 v200, v232, v208, v200
  v_bfi_b32 v201, v232, v208, v201
  v_bfi_b32 v202, v232, v208, v202
  v_bfi_b32 v203, v232, v208, v203
  v_mfma_f32_32x32x16_bf16 v[160:175], v[204:207], v[44:47], v[160:175]
  v_mfma_f32_32x32x16_bf16 v[144:159], v[180:183], v[208:211], v[144:159]
  v_mfma_f32_32x32x16_bf16 v[128:143], v[200:203], v[44:47], v[128:143]
  s_and_b32 s82, s78, 1
  s_lshl_b32 s82, s82, 10
  s_mul_i32 s83, s77, 1568
  s_add_u32 s83, s83, s82
  s_add_u32 m0, s82, 159744
  s_nop 0
  buffer_load_dwordx4 v2, s[16:19], s83 offen lds
  s_waitcnt vmcnt(7)
  s_barrier
  ds_read_b128 v[48:51], v246 offset:32768
  ds_read_b64_tr_b16 v[192:193], v250 offset:8192
  ds_read_b64_tr_b16 v[194:195], v250 offset:8448
  ds_read_b64_tr_b16 v[196:197], v251 offset:8192
  ds_read_b64_tr_b16 v[198:199], v251 offset:8448
  ds_read_b64_tr_b16 v[176:177], v252 offset:8192
  ds_read_b64_tr_b16 v[178:179], v252 offset:8448
  ds_read_b128 v[52:55], v247 offset:32768
  ds_read_b64_tr_b16 v[200:201], v250 offset:9216
  ds_read_b64_tr_b16 v[202:203], v250 offset:9472
  ds_read_b64_tr_b16 v[204:205], v251 offset:9216
  ds_read_b64_tr_b16 v[206:207], v251 offset:9472
  ds_read_b64_tr_b16 v[180:181], v252 offset:9216
  ds_read_b64_tr_b16 v[182:183], v252 offset:9472
  s_lshl_b32 s5, s3, 7
  s_add_u32 s5, s5, s85
  s_mul_i32 s91, s3, 172032
  s_add_u32 s91, s91, s86
  s_add_u32 s3, s3, 1
  s_cmp_eq_u32 s3, 7
  s_cselect_b32 s3, 0, s3
  s_add_u32 m0, s92, 65536
  s_nop 0
  buffer_load_dwordx4 v8, s[8:11], s5 offen offset:0 lds
  v_dot2c_f32_bf16 v224, v32, v32
  v_dot2c_f32_bf16 v225, v33, v33
  v_dot2c_f32_bf16 v226, v34, v34
  v_dot2c_f32_bf16 v227, v35, v35
  v_dot2c_f32_bf16 v224, v36, v36
  v_dot2c_f32_bf16 v225, v37, v37
  v_dot2c_f32_bf16 v226, v38, v38
  v_dot2c_f32_bf16 v227, v39, v39
  v_dot2c_f32_bf16 v224, v40, v40
  v_dot2c_f32_bf16 v225, v41, v41
  v_dot2c_f32_bf16 v226, v42, v42
  v_dot2c_f32_bf16 v227, v43, v43
  v_dot2c_f32_bf16 v224, v44, v44
  v_dot2c_f32_bf16 v225, v45, v45
  v_dot2c_f32_bf16 v226, v46, v46
  v_dot2c_f32_bf16 v227, v47, v47
  s_waitcnt lgkmcnt(7)
  v_bfi_b32 v192, v232, v208, v192
  v_bfi_b32 v193, v232, v208, v193
  v_bfi_b32 v194, v232, v208, v194
  v_bfi_b32 v195, v232, v208, v195
  v_mfma_f32_32x32x16_bf16 v[160:175], v[196:199], v[48:51], v[160:175]
  v_mfma_f32_32x32x16_bf16 v[144:159], v[176:179], v[208:211], v[144:159]
  v_mfma_f32_32x32x16_bf16 v[128:143], v[192:195], v[48:51], v[128:143]
  ds_read_b128 v[56:59], v248 offset:32768
  ds_read_b64_tr_b16 v[192:193], v250 offset:10240
  ds_read_b64_tr_b16 v[194:195], v250 offset:10496
  ds_read_b64_tr_b16 v[196:197], v251 offset:10240
  ds_read_b64_tr_b16 v[198:199], v251 offset:10496
  ds_read_b64_tr_b16 v[176:177], v252 offset:10240
  ds_read_b64_tr_b16 v[178:179], v252 offset:10496
  buffer_load_dwordx4 v9, s[8:11], s5 offen offset:1024 lds
  buffer_load_dwordx4 v228, s[8:11], s5 offen offset:2048 lds
  s_waitcnt lgkmcnt(7)
  v_bfi_b32 v200, v232, v208, v200
  v_bfi_b32 v201, v232, v208, v201
  v_bfi_b32 v202, v232, v208, v202
  v_bfi_b32 v203, v232, v208, v203
  v_mfma_f32_32x32x16_bf16 v[160:175], v[204:207], v[52:55], v[160:175]
  v_mfma_f32_32x32x16_bf16 v[144:159], v[180:183], v[208:211], v[144:159]
  v_mfma_f32_32x32x16_bf16 v[128:143], v[200:203], v[52:55], v[128:143]
  ds_read_b128 v[60:63], v249 offset:32768
  ds_read_b64_tr_b16 v[200:201], v250 offset:11264
  ds_read_b64_tr_b16 v[202:203], v250 offset:11520
  ds_read_b64_tr_b16 v[204:205], v251 offset:11264
  ds_read_b64_tr_b16 v[206:207], v251 offset:11520
  ds_read_b64_tr_b16 v[180:181], v252 offset:11264
  ds_read_b64_tr_b16 v[182:183], v252 offset:11520
  buffer_load_dwordx4 v229, s[8:11], s5 offen offset:3072 lds
  s_waitcnt lgkmcnt(7)
  v_bfi_b32 v192, v232, v208, v192
  v_bfi_b32 v193, v232, v208, v193
  v_bfi_b32 v194, v232, v208, v194
  v_bfi_b32 v195, v232, v208, v195
  v_mfma_f32_32x32x16_bf16 v[160:175], v[196:199], v[56:59], v[160:175]
  v_mfma_f32_32x32x16_bf16 v[144:159], v[176:179], v[208:211], v[144:159]
  v_mfma_f32_32x32x16_bf16 v[128:143], v[192:195], v[56:59], v[128:143]
  s_add_u32 m0, s87, 130176
  s_nop 0
  buffer_load_dwordx4 v255, s[12:15], s91 offen offset:896 lds
  s_add_u32 m0, s87, 14592
  s_nop 0
  buffer_load_dwordx4 v255, s[12:15], s91 offen offset:1792 lds
  s_waitcnt lgkmcnt(0)
  v_bfi_b32 v200, v232, v208, v200
  v_bfi_b32 v201, v232, v208, v201
  v_bfi_b32 v202, v232, v208, v202
  v_bfi_b32 v203, v232, v208, v203
  v_mfma_f32_32x32x16_bf16 v[160:175], v[204:207], v[60:63], v[160:175]
  v_mfma_f32_32x32x16_bf16 v[144:159], v[180:183], v[208:211], v[144:159]
  v_mfma_f32_32x32x16_bf16 v[128:143], v[200:203], v[60:63], v[128:143]
  s_waitcnt vmcnt(7)
  s_barrier
  ds_read_b128 v[64:67], v246 offset:49152
  ds_read_b64_tr_b16 v[192:193], v250 offset:12288
  ds_read_b64_tr_b16 v[194:195], v250 offset:12544
  ds_read_b64_tr_b16 v[196:197], v251 offset:12288
  ds_read_b64_tr_b16 v[198:199], v251 offset:12544
  ds_read_b64_tr_b16 v[176:177], v252 offset:12288
  ds_read_b64_tr_b16 v[178:179], v252 offset:12544
  ds_read_b128 v[68:71], v247 offset:49152
  ds_read_b64_tr_b16 v[200:201], v250 offset:13312
  ds_read_b64_tr_b16 v[202:203], v250 offset:13568
  ds_read_b64_tr_b16 v[204:205], v251 offset:13312
  ds_read_b64_tr_b16 v[206:207], v251 offset:13568
  ds_read_b64_tr_b16 v[180:181], v252 offset:13312
  ds_read_b64_tr_b16 v[182:183], v252 offset:13568
  s_lshl_b32 s5, s3, 7
  s_add_u32 s5, s5, s85
  s_mul_i32 s91, s3, 172032
  s_add_u32 s91, s91, s86
  s_add_u32 s3, s3, 1
  s_cmp_eq_u32 s3, 7
  s_cselect_b32 s3, 0, s3
  s_add_u32 m0, s92, 81920
  s_nop 0
  buffer_load_dwordx4 v8, s[8:11], s5 offen offset:0 lds
  v_dot2c_f32_bf16 v224, v48, v48
  v_dot2c_f32_bf16 v225, v49, v49
  v_dot2c_f32_bf16 v226, v50, v50
  v_dot2c_f32_bf16 v227, v51, v51
  v_dot2c_f32_bf16 v224, v52, v52
  v_dot2c_f32_bf16 v225, v53, v53
  v_dot2c_f32_bf16 v226, v54, v54
  v_dot2c_f32_bf16 v227, v55, v55
  v_dot2c_f32_bf16 v224, v56, v56
  v_dot2c_f32_bf16 v225, v57, v57
  v_dot2c_f32_bf16 v226, v58, v58
  v_dot2c_f32_bf16 v227, v59, v59
  v_dot2c_f32_bf16 v224, v60, v60
  v_dot2c_f32_bf16 v225, v61, v61
  v_dot2c_f32_bf16 v226, v62, v62
  v_dot2c_f32_bf16 v227, v63, v63
  s_waitcnt lgkmcnt(7)
  v_bfi_b32 v192, v232, v208, v192
  v_bfi_b32 v193, v232, v208, v193
  v_bfi_b32 v194, v232, v208, v194
  v_bfi_b32 v195, v232, v208, v195
  v_mfma_f32_32x32x16_bf16 v[160:175], v[196:199], v[64:67], v[160:175]
  v_mfma_f32_32x32x16_bf16 v[144:159], v[176:179], v[208:211], v[144:159]
  v_mfma_f32_32x32x16_bf16 v[128:143], v[192:195], v[64:67], v[128:143]
  ds_read_b128 v[72:75], v248 offset:49152
  ds_read_b64_tr_b16 v[192:193], v250 offset:14336
  ds_read_b64_tr_b16 v[194:195], v250 offset:14592
  ds_read_b64_tr_b16 v[196:197], v251 offset:14336
  ds_read_b64_tr_b16 v[198:199], v251 offset:14592
  ds_read_b64_tr_b16 v[176:177], v252 offset:14336
  ds_read_b64_tr_b16 v[178:179], v252 offset:14592
  buffer_load_dwordx4 v9, s[8:11], s5 offen offset:1024 lds
  buffer_load_dwordx4 v228, s[8:11], s5 offen offset:2048 lds
  s_waitcnt lgkmcnt(7)
  v_bfi_b32 v200, v232, v208, v200
  v_bfi_b32 v201, v232, v208, v201
  v_bfi_b32 v202, v232, v208, v202
  v_bfi_b32 v203, v232, v208, v203
  v_mfma_f32_32x32x16_bf16 v[160:175], v[204:207], v[68:71], v[160:175]
  v_mfma_f32_32x32x16_bf16 v[144:159], v[180:183], v[208:211], v[144:159]
  v_mfma_f32_32x32x16_bf16 v[128:143], v[200:203], v[68:71], v[128:143]
  ds_read_b128 v[76:79], v249 offset:49152
  ds_read_b64_tr_b16 v[200:201], v250 offset:15360
  ds_read_b64_tr_b16 v[202:203], v250 offset:15616
  ds_read_b64_tr_b16 v[204:205], v251 offset:15360
  ds_read_b64_tr_b16 v[206:207], v251 offset:15616
  ds_read_b64_tr_b16 v[180:181], v252 offset:15360
  ds_read_b64_tr_b16 v[182:183], v252 offset:15616
  buffer_load_dwordx4 v229, s[8:11], s5 offen offset:3072 lds
  s_waitcnt lgkmcnt(7)
  v_bfi_b32 v192, v232, v208, v192
  v_bfi_b32 v193, v232, v208, v193
  v_bfi_b32 v194, v232, v208, v194
  v_bfi_b32 v195, v232, v208, v195
  v_mfma_f32_32x32x16_bf16 v[160:175], v[196:199], v[72:75], v[160:175]
  v_mfma_f32_32x32x16_bf16 v[144:159], v[176:179], v[208:211], v[144:159]
  v_mfma_f32_32x32x16_bf16 v[128:143], v[192:195], v[72:75], v[128:143]
  s_add_u32 m0, s87, 134272
  s_nop 0
  buffer_load_dwordx4 v255, s[12:15], s91 offen offset:896 lds
  s_add_u32 m0, s87, 18688
  s_nop 0
  buffer_load_dwordx4 v255, s[12:15], s91 offen offset:1792 lds
  s_waitcnt lgkmcnt(0)
  v_bfi_b32 v200, v232, v208, v200
  v_bfi_b32 v201, v232, v208, v201
  v_bfi_b32 v202, v232, v208, v202
  v_bfi_b32 v203, v232, v208, v203
  v_mfma_f32_32x32x16_bf16 v[160:175], v[204:207], v[76:79], v[160:175]
  v_mfma_f32_32x32x16_bf16 v[144:159], v[180:183], v[208:211], v[144:159]
  v_mfma_f32_32x32x16_bf16 v[128:143], v[200:203], v[76:79], v[128:143]
  v_mov_b32 v15, 0
  buffer_load_dwordx2 v[230:231], v15, s[40:43], 0 offen
  s_waitcnt vmcnt(7)
  s_barrier
  v_add_u32 v246, 0x10000, v246
  v_add_u32 v247, 0x10000, v247
  v_add_u32 v248, 0x10000, v248
  v_add_u32 v249, 0x10000, v249
  v_add_u32 v251, 16384, v253
  s_and_b32 s82, s78, 1
  s_mul_i32 s82, s82, 4294823936
  v_add_u32 v252, s82, v252
  ds_read_b128 v[80:83], v246 offset:0
  ds_read_b64_tr_b16 v[192:193], v250 offset:16384
  ds_read_b64_tr_b16 v[194:195], v250 offset:16640
  ds_read_b64_tr_b16 v[196:197], v251 offset:0
  ds_read_b64_tr_b16 v[198:199], v251 offset:256
  ds_read_b64_tr_b16 v[176:177], v252 offset:16384
  ds_read_b64_tr_b16 v[178:179], v252 offset:16640
  ds_read_b128 v[84:87], v247 offset:0
  ds_read_b64_tr_b16 v[200:201], v250 offset:17408
  ds_read_b64_tr_b16 v[202:203], v250 offset:17664
  ds_read_b64_tr_b16 v[204:205], v251 offset:1024
  ds_read_b64_tr_b16 v[206:207], v251 offset:1280
  ds_read_b64_tr_b16 v[180:181], v252 offset:17408
  ds_read_b64_tr_b16 v[182:183], v252 offset:17664
  s_lshl_b32 s5, s3, 7
  s_add_u32 s5, s5, s85
  s_mul_i32 s91, s3, 172032
  s_add_u32 s91, s91, s86
  s_add_u32 s3, s3, 1
  s_cmp_eq_u32 s3, 7
  s_cselect_b32 s3, 0, s3
  s_add_u32 m0, s92, 98304
  s_nop 0
  buffer_load_dwordx4 v8, s[8:11], s5 offen offset:0 lds
  v_dot2c_f32_bf16 v224, v64, v64
  v_dot2c_f32_bf16 v225, v65, v65
  v_dot2c_f32_bf16 v226, v66, v66
  v_dot2c_f32_bf16 v227, v67, v67
  v_dot2c_f32_bf16 v224, v68, v68
  v_dot2c_f32_bf16 v225, v69, v69
  v_dot2c_f32_bf16 v226, v70, v70
  v_dot2c_f32_bf16 v227, v71, v71
  v_dot2c_f32_bf16 v224, v72, v72
  v_dot2c_f32_bf16 v225, v73, v73
  v_dot2c_f32_bf16 v226, v74, v74
  v_dot2c_f32_bf16 v227, v75, v75
  v_dot2c_f32_bf16 v224, v76, v76
  v_dot2c_f32_bf16 v225, v77, v77
  v_dot2c_f32_bf16 v226, v78, v78
  v_dot2c_f32_bf16 v227, v79, v79
  s_waitcnt lgkmcnt(7)
  v_bfi_b32 v192, v232, v208, v192
  v_bfi_b32 v193, v232, v208, v193
  v_bfi_b32 v194, v232, v208, v194
  v_bfi_b32 v195, v232, v208, v195
  v_mfma_f32_32x32x16_bf16 v[160:175], v[196:199], v[80:83], v[160:175]
  v_mfma_f32_32x32x16_bf16 v[144:159], v[176:179], v[208:211], v[144:159]
  v_mfma_f32_32x32x16_bf16 v[128:143], v[192:195], v[80:83], v[128:143]
  ds_read_b128 v[88:91], v248 offset:0
  ds_read_b64_tr_b16 v[192:193], v250 offset:18432
  ds_read_b64_tr_b16 v[194:195], v250 offset:18688
  ds_read_b64_tr_b16 v[196:197], v251 offset:2048
  ds_read_b64_tr_b16 v[198:199], v251 offset:2304
  ds_read_b64_tr_b16 v[176:177], v252 offset:18432
  ds_read_b64_tr_b16 v[178:179], v252 offset:18688
  buffer_load_dwordx4 v9, s[8:11], s5 offen offset:1024 lds
  buffer_load_dwordx4 v228, s[8:11], s5 offen offset:2048 lds
  s_waitcnt lgkmcnt(7)
  v_bfi_b32 v200, v232, v208, v200
  v_bfi_b32 v201, v232, v208, v201
  v_bfi_b32 v202, v232, v208, v202
  v_bfi_b32 v203, v232, v208, v203
  v_mfma_f32_32x32x16_bf16 v[160:175], v[204:207], v[84:87], v[160:175]
  v_mfma_f32_32x32x16_bf16 v[144:159], v[180:183], v[208:211], v[144:159]
  v_mfma_f32_32x32x16_bf16 v[128:143], v[200:203], v[84:87], v[128:143]
  ds_read_b128 v[92:95], v249 offset:0
  ds_read_b64_tr_b16 v[200:201], v250 offset:19456
  ds_read_b64_tr_b16 v[202:203], v250 offset:19712
  ds_read_b64_tr_b16 v[204:205], v251 offset:3072
  ds_read_b64_tr_b16 v[206:207], v251 offset:3328
  ds_read_b64_tr_b16 v[180:181], v252 offset:19456
  ds_read_b64_tr_b16 v[182:183], v252 offset:19712
  buffer_load_dwordx4 v229, s[8:11], s5 offen offset:3072 lds
  s_waitcnt lgkmcnt(7)
  v_bfi_b32 v192, v232, v208, v192
  v_bfi_b32 v193, v232, v208, v193
  v_bfi_b32 v194, v232, v208, v194
  v_bfi_b32 v195, v232, v208, v195
  v_mfma_f32_32x32x16_bf16 v[160:175], v[196:199], v[88:91], v[160:175]
  v_mfma_f32_32x32x16_bf16 v[144:159], v[176:179], v[208:211], v[144:159]
  v_mfma_f32_32x32x16_bf16 v[128:143], v[192:195], v[88:91], v[128:143]
  s_add_u32 m0, s87, 138368
  s_nop 0
  buffer_load_dwordx4 v255, s[12:15], s91 offen offset:896 lds
  s_add_u32 m0, s87, 22784
  s_nop 0
  buffer_load_dwordx4 v255, s[12:15], s91 offen offset:1792 lds
  s_waitcnt lgkmcnt(0)
  v_bfi_b32 v200, v232, v208, v200
  v_bfi_b32 v201, v232, v208, v201
  v_bfi_b32 v202, v232, v208, v202
  v_bfi_b32 v203, v232, v208, v203
  v_mfma_f32_32x32x16_bf16 v[160:175], v[204:207], v[92:95], v[160:175]
  v_mfma_f32_32x32x16_bf16 v[144:159], v[180:183], v[208:211], v[144:159]
  v_mfma_f32_32x32x16_bf16 v[128:143], v[200:203], v[92:95], v[128:143]
  s_waitcnt vmcnt(7)
  s_barrier
  ds_read_b128 v[96:99], v246 offset:16384
  ds_read_b64_tr_b16 v[192:193], v250 offset:20480
  ds_read_b64_tr_b16 v[194:195], v250 offset:20736
  ds_read_b64_tr_b16 v[196:197], v251 offset:4096
  ds_read_b64_tr_b16 v[198:199], v251 offset:4352
  ds_read_b64_tr_b16 v[176:177], v252 offset:20480
  ds_read_b64_tr_b16 v[178:179], v252 offset:20736
  ds_read_b128 v[100:103], v247 offset:16384
  ds_read_b64_tr_b16 v[200:201], v250 offset:21504
  ds_read_b64_tr_b16 v[202:203], v250 offset:21760
  ds_read_b64_tr_b16 v[204:205], v251 offset:5120
  ds_read_b64_tr_b16 v[206:207], v251 offset:5376
  ds_read_b64_tr_b16 v[180:181], v252 offset:21504
  ds_read_b64_tr_b16 v[182:183], v252 offset:21760
  v_bfe_u32 v7, v1, 2, 2
  v_lshl_add_u32 v7, v3, 2, v7
  v_mul_u32_u24 v7, 56, v7
  v_bfe_u32 v11, v1, 4, 1
  v_lshl_add_u32 v7, v11, 5, v7
  v_and_b32 v11, 3, v1
  v_lshl_add_u32 v7, v11, 3, v7
  v_add_u32 v7, 159744, v7
  ds_read_b64_tr_b16 v[212:213], v7 offset:0
  s_waitcnt lgkmcnt(14)
  ds_read_b64_tr_b16 v[214:215], v7 offset:448
  s_waitcnt lgkmcnt(14)
  ds_read_b64_tr_b16 v[216:217], v7 offset:896
  s_waitcnt lgkmcnt(14)
  ds_read_b64_tr_b16 v[218:219], v7 offset:1344
  s_mov_b32 s3, s95
  s_mul_i32 s91, s3, 172032
  s_add_u32 s91, s91, s86
  s_add_u32 s3, s3, 1
  s_cmp_eq_u32 s3, 7
  s_cselect_b32 s3, 0, s3
  s_add_u32 m0, s87, 40960
  s_add_u32 s81, s91, 0
  buffer_load_dwordx4 v255, s[12:15], s81 offen lds
  v_dot2c_f32_bf16 v224, v80, v80
  v_dot2c_f32_bf16 v225, v81, v81
  v_dot2c_f32_bf16 v226, v82, v82
  v_dot2c_f32_bf16 v227, v83, v83
  v_dot2c_f32_bf16 v224, v84, v84
  v_dot2c_f32_bf16 v225, v85, v85
  v_dot2c_f32_bf16 v226, v86, v86
  v_dot2c_f32_bf16 v227, v87, v87
  v_dot2c_f32_bf16 v224, v88, v88
  v_dot2c_f32_bf16 v225, v89, v89
  v_dot2c_f32_bf16 v226, v90, v90
  v_dot2c_f32_bf16 v227, v91, v91
  v_dot2c_f32_bf16 v224, v92, v92
  v_dot2c_f32_bf16 v225, v93, v93
  v_dot2c_f32_bf16 v226, v94, v94
  v_dot2c_f32_bf16 v227, v95, v95
  s_waitcnt lgkmcnt(11)
  v_bfi_b32 v192, v232, v208, v192
  v_bfi_b32 v193, v232, v208, v193
  v_bfi_b32 v194, v232, v208, v194
  v_bfi_b32 v195, v232, v208, v195
  v_mfma_f32_32x32x16_bf16 v[160:175], v[196:199], v[96:99], v[160:175]
  v_mfma_f32_32x32x16_bf16 v[144:159], v[176:179], v[208:211], v[144:159]
  v_mfma_f32_32x32x16_bf16 v[128:143], v[192:195], v[96:99], v[128:143]
  ds_read_b128 v[104:107], v248 offset:16384
  ds_read_b64_tr_b16 v[192:193], v250 offset:22528
  ds_read_b64_tr_b16 v[194:195], v250 offset:22784
  ds_read_b64_tr_b16 v[196:197], v251 offset:6144
  s_waitcnt lgkmcnt(14)
  ds_read_b64_tr_b16 v[198:199], v251 offset:6400
  s_waitcnt lgkmcnt(14)
  ds_read_b64_tr_b16 v[176:177], v252 offset:22528
  s_waitcnt lgkmcnt(14)
  ds_read_b64_tr_b16 v[178:179], v252 offset:22784
  s_mul_i32 s91, s3, 172032
  s_add_u32 s91, s91, s86
  s_add_u32 s3, s3, 1
  s_cmp_eq_u32 s3, 7
  s_cselect_b32 s3, 0, s3
  s_add_u32 m0, s87, 45056
  s_add_u32 s81, s91, 0
  buffer_load_dwordx4 v255, s[12:15], s81 offen lds
  s_mul_i32 s91, s3, 172032
  s_add_u32 s91, s91, s86
  s_add_u32 s3, s3, 1
  s_cmp_eq_u32 s3, 7
  s_cselect_b32 s3, 0, s3
  s_add_u32 m0, s87, 49152
  s_add_u32 s81, s91, 0
  buffer_load_dwordx4 v255, s[12:15], s81 offen lds
  s_waitcnt lgkmcnt(11)
  v_bfi_b32 v200, v232, v208, v200
  v_bfi_b32 v201, v232, v208, v201
  v_bfi_b32 v202, v232, v208, v202
  v_bfi_b32 v203, v232, v208, v203
  v_mfma_f32_32x32x16_bf16 v[160:175], v[204:207], v[100:103], v[160:175]
  v_mfma_f32_32x32x16_bf16 v[144:159], v[180:183], v[208:211], v[144:159]
  v_mfma_f32_32x32x16_bf16 v[128:143], v[200:203], v[100:103], v[128:143]
  ds_read_b128 v[108:111], v249 offset:16384
  ds_read_b64_tr_b16 v[200:201], v250 offset:23552
  ds_read_b64_tr_b16 v[202:203], v250 offset:23808
  ds_read_b64_tr_b16 v[204:205], v251 offset:7168
  s_waitcnt lgkmcnt(14)
  ds_read_b64_tr_b16 v[206:207], v251 offset:7424
  s_waitcnt lgkmcnt(14)
  ds_read_b64_tr_b16 v[180:181], v252 offset:23552
  s_waitcnt lgkmcnt(14)
  ds_read_b64_tr_b16 v[182:183], v252 offset:23808
  s_waitcnt lgkmcnt(7)
  v_bfi_b32 v192, v232, v208, v192
  v_bfi_b32 v193, v232, v208, v193
  v_bfi_b32 v194, v232, v208, v194
  v_bfi_b32 v195, v232, v208, v195
  v_mfma_f32_32x32x16_bf16 v[160:175], v[196:199], v[104:107], v[160:175]
  v_mfma_f32_32x32x16_bf16 v[144:159], v[176:179], v[208:211], v[144:159]
  v_mfma_f32_32x32x16_bf16 v[128:143], v[192:195], v[104:107], v[128:143]
  s_waitcnt lgkmcnt(0)
  v_bfi_b32 v200, v232, v208, v200
  v_bfi_b32 v201, v232, v208, v201
  v_bfi_b32 v202, v232, v208, v202
  v_bfi_b32 v203, v232, v208, v203
  v_mfma_f32_32x32x16_bf16 v[160:175], v[204:207], v[108:111], v[160:175]
  v_mfma_f32_32x32x16_bf16 v[144:159], v[180:183], v[208:211], v[144:159]
  v_mfma_f32_32x32x16_bf16 v[128:143], v[200:203], v[108:111], v[128:143]
  s_waitcnt vmcnt(3)
  s_barrier
  ds_read_b128 v[112:115], v246 offset:32768
  ds_read_b64_tr_b16 v[192:193], v250 offset:24576
  ds_read_b64_tr_b16 v[194:195], v250 offset:24832
  ds_read_b64_tr_b16 v[196:197], v251 offset:8192
  ds_read_b64_tr_b16 v[198:199], v251 offset:8448
  ds_read_b64_tr_b16 v[176:177], v252 offset:24576
  ds_read_b64_tr_b16 v[178:179], v252 offset:24832
  ds_read_b128 v[116:119], v247 offset:32768
  ds_read_b64_tr_b16 v[200:201], v250 offset:25600
  ds_read_b64_tr_b16 v[202:203], v250 offset:25856
  ds_read_b64_tr_b16 v[204:205], v251 offset:9216
  ds_read_b64_tr_b16 v[206:207], v251 offset:9472
  ds_read_b64_tr_b16 v[180:181], v252 offset:25600
  ds_read_b64_tr_b16 v[182:183], v252 offset:25856
  s_mul_i32 s91, s3, 172032
  s_add_u32 s91, s91, s86
  s_add_u32 s3, s3, 1
  s_cmp_eq_u32 s3, 7
  s_cselect_b32 s3, 0, s3
  s_add_u32 m0, s87, 53248
  s_add_u32 s81, s91, 0
  buffer_load_dwordx4 v255, s[12:15], s81 offen lds
  v_dot2c_f32_bf16 v224, v96, v96
  v_dot2c_f32_bf16 v225, v97, v97
  v_dot2c_f32_bf16 v226, v98, v98
  v_dot2c_f32_bf16 v227, v99, v99
  v_dot2c_f32_bf16 v224, v100, v100
  v_dot2c_f32_bf16 v225, v101, v101
  v_dot2c_f32_bf16 v226, v102, v102
  v_dot2c_f32_bf16 v227, v103, v103
  v_dot2c_f32_bf16 v224, v104, v104
  v_dot2c_f32_bf16 v225, v105, v105
  v_dot2c_f32_bf16 v226, v106, v106
  v_dot2c_f32_bf16 v227, v107, v107
  v_dot2c_f32_bf16 v224, v108, v108
  v_dot2c_f32_bf16 v225, v109, v109
  v_dot2c_f32_bf16 v226, v110, v110
  v_dot2c_f32_bf16 v227, v111, v111
  s_waitcnt lgkmcnt(7)
  v_bfi_b32 v192, v232, v208, v192
  v_bfi_b32 v193, v232, v208, v193
  v_bfi_b32 v194, v232, v208, v194
  v_bfi_b32 v195, v232, v208, v195
  v_mfma_f32_32x32x16_bf16 v[160:175], v[196:199], v[112:115], v[160:175]
  v_mfma_f32_32x32x16_bf16 v[144:159], v[176:179], v[208:211], v[144:159]
  v_mfma_f32_32x32x16_bf16 v[128:143], v[192:195], v[112:115], v[128:143]
  ds_read_b128 v[120:123], v248 offset:32768
  ds_read_b64_tr_b16 v[192:193], v250 offset:26624
  ds_read_b64_tr_b16 v[194:195], v250 offset:26880
  ds_read_b64_tr_b16 v[196:197], v251 offset:10240
  ds_read_b64_tr_b16 v[198:199], v251 offset:10496
  ds_read_b64_tr_b16 v[176:177], v252 offset:26624
  ds_read_b64_tr_b16 v[178:179], v252 offset:26880
  s_mul_i32 s91, s3, 172032
  s_add_u32 s91, s91, s86
  s_add_u32 s3, s3, 1
  s_cmp_eq_u32 s3, 7
  s_cselect_b32 s3, 0, s3
  s_add_u32 m0, s87, 57344
  s_add_u32 s81, s91, 0
  buffer_load_dwordx4 v255, s[12:15], s81 offen lds
  s_mul_i32 s91, s3, 172032
  s_add_u32 s91, s91, s86
  s_add_u32 s3, s3, 1
  s_cmp_eq_u32 s3, 7
  s_cselect_b32 s3, 0, s3
  s_add_u32 m0, s87, 61440
  s_add_u32 s81, s91, 0
  buffer_load_dwordx4 v255, s[12:15], s81 offen lds
  s_waitcnt lgkmcnt(7)
  v_bfi_b32 v200, v232, v208, v200
  v_bfi_b32 v201, v232, v208, v201
  v_bfi_b32 v202, v232, v208, v202
  v_bfi_b32 v203, v232, v208, v203
  v_mfma_f32_32x32x16_bf16 v[160:175], v[204:207], v[116:119], v[160:175]
  v_mfma_f32_32x32x16_bf16 v[144:159], v[180:183], v[208:211], v[144:159]
  v_mfma_f32_32x32x16_bf16 v[128:143], v[200:203], v[116:119], v[128:143]
  ds_read_b128 v[124:127], v249 offset:32768
  ds_read_b64_tr_b16 v[200:201], v250 offset:27648
  ds_read_b64_tr_b16 v[202:203], v250 offset:27904
  ds_read_b64_tr_b16 v[204:205], v251 offset:11264
  ds_read_b64_tr_b16 v[206:207], v251 offset:11520
  ds_read_b64_tr_b16 v[180:181], v252 offset:27648
  ds_read_b64_tr_b16 v[182:183], v252 offset:27904
  s_mul_i32 s91, s3, 172032
  s_add_u32 s91, s91, s86
  s_add_u32 s3, s3, 1
  s_cmp_eq_u32 s3, 7
  s_cselect_b32 s3, 0, s3
  s_add_u32 m0, s87, 65536
  s_add_u32 s81, s91, 0
  buffer_load_dwordx4 v255, s[12:15], s81 offen lds
  s_waitcnt lgkmcnt(7)
  v_bfi_b32 v192, v232, v208, v192
  v_bfi_b32 v193, v232, v208, v193
  v_bfi_b32 v194, v232, v208, v194
  v_bfi_b32 v195, v232, v208, v195
  v_mfma_f32_32x32x16_bf16 v[160:175], v[196:199], v[120:123], v[160:175]
  v_mfma_f32_32x32x16_bf16 v[144:159], v[176:179], v[208:211], v[144:159]
  v_mfma_f32_32x32x16_bf16 v[128:143], v[192:195], v[120:123], v[128:143]
  s_waitcnt lgkmcnt(0)
  v_bfi_b32 v200, v232, v208, v200
  v_bfi_b32 v201, v232, v208, v201
  v_bfi_b32 v202, v232, v208, v202
  v_bfi_b32 v203, v232, v208, v203
  v_mfma_f32_32x32x16_bf16 v[160:175], v[204:207], v[124:127], v[160:175]
  v_mfma_f32_32x32x16_bf16 v[144:159], v[180:183], v[208:211], v[144:159]
  v_mfma_f32_32x32x16_bf16 v[128:143], v[200:203], v[124:127], v[128:143]
  v_dot2c_f32_bf16 v224, v112, v112
  v_dot2c_f32_bf16 v225, v113, v113
  v_dot2c_f32_bf16 v226, v114, v114
  v_dot2c_f32_bf16 v227, v115, v115
  v_dot2c_f32_bf16 v224, v116, v116
  v_dot2c_f32_bf16 v225, v117, v117
  v_dot2c_f32_bf16 v226, v118, v118
  v_dot2c_f32_bf16 v227, v119, v119
  v_dot2c_f32_bf16 v224, v120, v120
  v_dot2c_f32_bf16 v225, v121, v121
  v_dot2c_f32_bf16 v226, v122, v122
  v_dot2c_f32_bf16 v227, v123, v123
  v_dot2c_f32_bf16 v224, v124, v124
  v_dot2c_f32_bf16 v225, v125, v125
  v_dot2c_f32_bf16 v226, v126, v126
  v_dot2c_f32_bf16 v227, v127, v127
  s_cmp_ge_u32 s78, 2
  s_cbranch_scc1 L_cs_2
  s_lshl_b32 s82, s78, 7
  v_lshlrev_b32 v7, 4, v3
  v_add_u32 v7, s82, v7
  v_add_u32 v7, 69888, v7
  s_mov_b64 s[100:101], exec
  s_mov_b32 exec_lo, 1
  s_mov_b32 exec_hi, 1
  ds_write_b128 v7, v[144:147] offset:0
  ds_write_b128 v7, v[148:151] offset:32
  ds_write_b128 v7, v[152:155] offset:64
  ds_write_b128 v7, v[156:159] offset:96
  s_mov_b64 exec, s[100:101]
  s_waitcnt lgkmcnt(0)
L_cs_2:
  s_barrier
  v_readfirstlane_b32 s80, v230
  v_readfirstlane_b32 s96, v231
  s_mov_b32 s88, 0
  s_cmp_lg_u32 s80, 0
  s_cbranch_scc1 L_nd_4
  v_mov_b32 v15, 0
L_np_3:
  buffer_load_dwordx2 v[230:231], v15, s[40:43], 0 offen sc1
  s_waitcnt vmcnt(0)
  v_readfirstlane_b32 s80, v230
  v_readfirstlane_b32 s96, v231
  s_add_u32 s88, s88, 1
  s_cmp_ge_u32 s88, 0x100000
  s_cbranch_scc1 L_nd_4
  s_cmp_eq_u32 s80, 0
  s_cbranch_scc1 L_np_3
L_nd_4:
  s_getreg_b32 s97, hwreg(HW_REG_XCC_ID, 0, 3)
  s_or_b32 s97, s97, s80
  v_lshlrev_b32 v7, 4, v3
  v_add_u32 v7, 69888, v7
  ds_read_b128 v[176:179], v7 offset:128
  ds_read_b128 v[180:183], v7 offset:160
  ds_read_b128 v[184:187], v7 offset:192
  ds_read_b128 v[188:191], v7 offset:224
  ds_read_b128 v[144:147], v7 offset:0
  ds_read_b128 v[148:151], v7 offset:32
  ds_read_b128 v[152:155], v7 offset:64
  ds_read_b128 v[156:159], v7 offset:96
  v_mov_b32 v220, v140
  v_mov_b32 v221, v140
  v_add_f32 v224, v224, v225
  v_add_f32 v226, v226, v227
  v_permlane32_swap_b32 v220, v221
  v_add_f32 v224, v224, v226
  v_mov_b32 v225, v224
  s_nop 1
  v_permlane32_swap_b32 v224, v225
  v_add_f32 v224, v224, v225
  v_mul_f32 v244, 2.2321428571e-03, v221
  v_mul_f32 v222, 2.2321428571e-03, v224
  v_fma_f32 v222, -v244, v244, v222
  v_max_f32 v222, 0, v222
  v_add_f32 v222, 0x3727c5ac, v222
  v_rsq_f32 v245, v222
  s_waitcnt lgkmcnt(4)
  v_sub_f32 v8, 0, v244
  v_pk_fma_f32 v[160:161], v[8:9], v[176:177], v[160:161] op_sel_hi:[0,1,1]
  v_pk_fma_f32 v[162:163], v[8:9], v[178:179], v[162:163] op_sel_hi:[0,1,1]
  v_pk_fma_f32 v[164:165], v[8:9], v[180:181], v[164:165] op_sel_hi:[0,1,1]
  v_pk_fma_f32 v[166:167], v[8:9], v[182:183], v[166:167] op_sel_hi:[0,1,1]
  v_pk_fma_f32 v[168:169], v[8:9], v[184:185], v[168:169] op_sel_hi:[0,1,1]
  v_pk_fma_f32 v[170:171], v[8:9], v[186:187], v[170:171] op_sel_hi:[0,1,1]
  v_pk_fma_f32 v[172:173], v[8:9], v[188:189], v[172:173] op_sel_hi:[0,1,1]
  v_pk_fma_f32 v[174:175], v[8:9], v[190:191], v[174:175] op_sel_hi:[0,1,1]
  v_pk_mul_f32 v[160:161], v[160:161], v[244:245] op_sel:[0,1] op_sel_hi:[1,1]
  v_pk_mul_f32 v[162:163], v[162:163], v[244:245] op_sel:[0,1] op_sel_hi:[1,1]
  v_pk_mul_f32 v[164:165], v[164:165], v[244:245] op_sel:[0,1] op_sel_hi:[1,1]
  v_pk_mul_f32 v[166:167], v[166:167], v[244:245] op_sel:[0,1] op_sel_hi:[1,1]
  v_pk_mul_f32 v[168:169], v[168:169], v[244:245] op_sel:[0,1] op_sel_hi:[1,1]
  v_pk_mul_f32 v[170:171], v[170:171], v[244:245] op_sel:[0,1] op_sel_hi:[1,1]
  v_pk_mul_f32 v[172:173], v[172:173], v[244:245] op_sel:[0,1] op_sel_hi:[1,1]
  v_pk_mul_f32 v[174:175], v[174:175], v[244:245] op_sel:[0,1] op_sel_hi:[1,1]
  v_cvt_pk_bf16_f32 v176, v160, v161
  v_cvt_pk_bf16_f32 v177, v162, v163
  v_cvt_pk_bf16_f32 v178, v164, v165
  v_cvt_pk_bf16_f32 v179, v166, v167
  v_cvt_pk_bf16_f32 v180, v168, v169
  v_cvt_pk_bf16_f32 v181, v170, v171
  v_cvt_pk_bf16_f32 v182, v172, v173
  v_cvt_pk_bf16_f32 v183, v174, v175
  v_and_b32 v182, v4, v182
  v_and_b32 v183, v4, v183
  v_lshrrev_b32 v7, 16, v6
  v_and_b32 v7, 0x3f80, v7
  v_or_b32 v182, v182, v7
  v_accvgpr_read_b32 v11, a1
  v_xor_b32 v12, 0, v11
  ds_write_b64 v12, v[176:177]
  v_xor_b32 v12, 16, v11
  ds_write_b64 v12, v[178:179]
  v_xor_b32 v12, 32, v11
  ds_write_b64 v12, v[180:181]
  v_xor_b32 v12, 48, v11
  ds_write_b64 v12, v[182:183]
  s_waitcnt lgkmcnt(4)
  v_sub_f32 v8, 0, v244
  v_pk_fma_f32 v[128:129], v[8:9], v[144:145], v[128:129] op_sel_hi:[0,1,1]
  v_pk_fma_f32 v[130:131], v[8:9], v[146:147], v[130:131] op_sel_hi:[0,1,1]
  v_pk_fma_f32 v[132:133], v[8:9], v[148:149], v[132:133] op_sel_hi:[0,1,1]
  v_pk_fma_f32 v[134:135], v[8:9], v[150:151], v[134:135] op_sel_hi:[0,1,1]
  v_pk_fma_f32 v[136:137], v[8:9], v[152:153], v[136:137] op_sel_hi:[0,1,1]
  v_pk_fma_f32 v[138:139], v[8:9], v[154:155], v[138:139] op_sel_hi:[0,1,1]
  v_pk_fma_f32 v[140:141], v[8:9], v[156:157], v[140:141] op_sel_hi:[0,1,1]
  v_pk_fma_f32 v[142:143], v[8:9], v[158:159], v[142:143] op_sel_hi:[0,1,1]
  v_pk_mul_f32 v[128:129], v[128:129], v[244:245] op_sel:[0,1] op_sel_hi:[1,1]
  v_pk_mul_f32 v[130:131], v[130:131], v[244:245] op_sel:[0,1] op_sel_hi:[1,1]
  v_pk_mul_f32 v[132:133], v[132:133], v[244:245] op_sel:[0,1] op_sel_hi:[1,1]
  v_pk_mul_f32 v[134:135], v[134:135], v[244:245] op_sel:[0,1] op_sel_hi:[1,1]
  v_pk_mul_f32 v[136:137], v[136:137], v[244:245] op_sel:[0,1] op_sel_hi:[1,1]
  v_pk_mul_f32 v[138:139], v[138:139], v[244:245] op_sel:[0,1] op_sel_hi:[1,1]
  v_pk_mul_f32 v[140:141], v[140:141], v[244:245] op_sel:[0,1] op_sel_hi:[1,1]
  v_pk_mul_f32 v[142:143], v[142:143], v[244:245] op_sel:[0,1] op_sel_hi:[1,1]
  v_cvt_pk_bf16_f32 v192, v128, v129
  v_cvt_pk_bf16_f32 v193, v130, v131
  v_cvt_pk_bf16_f32 v194, v132, v133
  v_cvt_pk_bf16_f32 v195, v134, v135
  v_cvt_pk_bf16_f32 v196, v136, v137
  v_cvt_pk_bf16_f32 v197, v138, v139
  v_cvt_pk_bf16_f32 v198, v140, v141
  v_cvt_pk_bf16_f32 v199, v142, v143
  v_and_b32 v198, v4, v198
  v_and_b32 v199, v4, v199
  v_mfma_f32_32x32x16_bf16 v[144:159], v[212:215], v[192:195], 0
  s_nop 0
  v_mfma_f32_32x32x16_bf16 v[144:159], v[216:219], v[196:199], v[144:159]
  s_mul_i32 s81, s2, 6272
  s_mul_i32 s82, s78, 1600
  s_add_u32 s81, s81, s82
  v_min_u32 v13, 24, v1
  v_lshlrev_b32 v13, 6, v13
  buffer_load_dword a6, v13, s[24:27], s81 offen
  s_mul_i32 s81, s2, 6272
  s_mul_i32 s82, s78, 1600
  s_add_u32 s81, s81, s82
  v_min_u32 v13, 24, v1
  v_lshlrev_b32 v13, 6, v13
  buffer_load_dword a7, v13, s[28:31], s81 offen
  s_mul_i32 s81, s2, 1568
  s_mul_i32 s82, s78, 448
  s_add_u32 s81, s81, s82
  v_min_u32 v13, 6, v1
  v_lshlrev_b32 v13, 6, v13
  buffer_load_dword a8, v13, s[20:23], s81 offen
  v_max3_f32 v8, v144, v145, v146
  v_min3_f32 v9, v144, v145, v146
  v_max3_f32 v8, v8, v147, v148
  v_min3_f32 v9, v9, v147, v148
  v_max3_f32 v8, v8, v149, v150
  v_min3_f32 v9, v9, v149, v150
  v_max3_f32 v8, v8, v151, v152
  v_min3_f32 v9, v9, v151, v152
  v_max3_f32 v8, v8, v153, v154
  v_min3_f32 v9, v9, v153, v154
  v_max_f32 v8, v8, v155
  v_min_f32 v9, v9, v155
  v_max3_f32 v10, v156, v157, v158
  v_min3_f32 v11, v156, v157, v158
  v_max_f32 v10, v10, v159
  v_min_f32 v11, v11, v159
  v_add_f32 v10, v10, v5
  v_add_f32 v11, v11, v6
  v_max_f32 v8, v8, v10
  v_min_f32 v9, v9, v11
  v_mov_b32 v10, v8
  s_nop 1
  v_permlane32_swap_b32 v8, v10
  v_max_f32 v8, v8, v10
  v_mov_b32 v11, v9
  s_nop 1
  v_permlane32_swap_b32 v9, v11
  v_min_f32 v9, v9, v11
  s_mov_b32 s85, 0x3fb8aa3b
  s_mov_b32 s5, 0xbfb8aa3b
  v_mul_f32 v8, s5, v8
  v_mul_f32 v9, s85, v9
  v_add_f32 v10, v8, v5
  v_add_f32 v11, v9, v5
  v_fma_f32 v128, v144, s85, v8
  v_fma_f32 v228, v144, s5, v9
  v_fma_f32 v129, v145, s85, v8
  v_fma_f32 v229, v145, s5, v9
  v_fma_f32 v130, v146, s85, v8
  v_fma_f32 v230, v146, s5, v9
  v_fma_f32 v131, v147, s85, v8
  v_fma_f32 v231, v147, s5, v9
  v_fma_f32 v132, v148, s85, v8
  v_fma_f32 v232, v148, s5, v9
  v_fma_f32 v133, v149, s85, v8
  v_fma_f32 v233, v149, s5, v9
  v_fma_f32 v134, v150, s85, v8
  v_fma_f32 v234, v150, s5, v9
  v_fma_f32 v135, v151, s85, v8
  v_fma_f32 v235, v151, s5, v9
  v_fma_f32 v136, v152, s85, v8
  v_fma_f32 v236, v152, s5, v9
  v_fma_f32 v137, v153, s85, v8
  v_fma_f32 v237, v153, s5, v9
  v_fma_f32 v138, v154, s85, v8
  v_fma_f32 v238, v154, s5, v9
  v_fma_f32 v139, v155, s85, v8
  v_fma_f32 v239, v155, s5, v9
  v_fma_f32 v140, v156, s85, v10
  v_fma_f32 v240, v156, s5, v11
  v_fma_f32 v141, v157, s85, v10
  v_fma_f32 v241, v157, s5, v11
  v_fma_f32 v142, v158, s85, v10
  v_fma_f32 v242, v158, s5, v11
  v_fma_f32 v143, v159, s85, v10
  v_fma_f32 v243, v159, s5, v11
  v_exp_f32 v128, v128
  v_exp_f32 v228, v228
  v_exp_f32 v129, v129
  v_exp_f32 v229, v229
  v_exp_f32 v130, v130
  v_exp_f32 v230, v230
  v_exp_f32 v131, v131
  v_exp_f32 v231, v231
  v_exp_f32 v132, v132
  v_exp_f32 v232, v232
  v_exp_f32 v133, v133
  v_exp_f32 v233, v233
  v_exp_f32 v134, v134
  v_exp_f32 v234, v234
  v_exp_f32 v135, v135
  v_exp_f32 v235, v235
  v_exp_f32 v136, v136
  v_exp_f32 v236, v236
  v_exp_f32 v137, v137
  v_exp_f32 v237, v237
  v_exp_f32 v138, v138
  v_exp_f32 v238, v238
  v_exp_f32 v139, v139
  v_exp_f32 v239, v239
  v_exp_f32 v140, v140
  v_exp_f32 v240, v240
  v_exp_f32 v141, v141
  v_exp_f32 v241, v241
  v_exp_f32 v142, v142
  v_exp_f32 v242, v242
  v_exp_f32 v143, v143
  v_exp_f32 v243, v243
  v_pk_add_f32 v[8:9], v[128:129], v[130:131]
  v_pk_add_f32 v[8:9], v[8:9], v[132:133]
  v_pk_add_f32 v[8:9], v[8:9], v[134:135]
  v_pk_add_f32 v[8:9], v[8:9], v[136:137]
  v_pk_add_f32 v[8:9], v[8:9], v[138:139]
  v_pk_add_f32 v[8:9], v[8:9], v[140:141]
  v_pk_add_f32 v[8:9], v[8:9], v[142:143]
  v_add_f32 v8, v8, v9
  v_pk_add_f32 v[10:11], v[228:229], v[230:231]
  v_pk_add_f32 v[10:11], v[10:11], v[232:233]
  v_pk_add_f32 v[10:11], v[10:11], v[234:235]
  v_pk_add_f32 v[10:11], v[10:11], v[236:237]
  v_pk_add_f32 v[10:11], v[10:11], v[238:239]
  v_pk_add_f32 v[10:11], v[10:11], v[240:241]
  v_pk_add_f32 v[10:11], v[10:11], v[242:243]
  v_add_f32 v10, v10, v11
  v_mov_b32 v9, v8
  s_nop 1
  v_permlane32_swap_b32 v8, v9
  v_add_f32 v8, v8, v9
  v_mov_b32 v11, v10
  s_nop 1
  v_permlane32_swap_b32 v10, v11
  v_add_f32 v10, v10, v11
  v_rcp_f32 v8, v8
  v_rcp_f32 v10, v10
  v_pk_mul_f32 v[128:129], v[128:129], v[8:9] op_sel_hi:[1,0]
  v_pk_mul_f32 v[228:229], v[228:229], v[10:11] op_sel_hi:[1,0]
  v_pk_mul_f32 v[130:131], v[130:131], v[8:9] op_sel_hi:[1,0]
  v_pk_mul_f32 v[230:231], v[230:231], v[10:11] op_sel_hi:[1,0]
  v_pk_mul_f32 v[132:133], v[132:133], v[8:9] op_sel_hi:[1,0]
  v_pk_mul_f32 v[232:233], v[232:233], v[10:11] op_sel_hi:[1,0]
  v_pk_mul_f32 v[134:135], v[134:135], v[8:9] op_sel_hi:[1,0]
  v_pk_mul_f32 v[234:235], v[234:235], v[10:11] op_sel_hi:[1,0]
  v_pk_mul_f32 v[136:137], v[136:137], v[8:9] op_sel_hi:[1,0]
  v_pk_mul_f32 v[236:237], v[236:237], v[10:11] op_sel_hi:[1,0]
  v_pk_mul_f32 v[138:139], v[138:139], v[8:9] op_sel_hi:[1,0]
  v_pk_mul_f32 v[238:239], v[238:239], v[10:11] op_sel_hi:[1,0]
  v_pk_mul_f32 v[140:141], v[140:141], v[8:9] op_sel_hi:[1,0]
  v_pk_mul_f32 v[240:241], v[240:241], v[10:11] op_sel_hi:[1,0]
  v_pk_mul_f32 v[142:143], v[142:143], v[8:9] op_sel_hi:[1,0]
  v_pk_mul_f32 v[242:243], v[242:243], v[10:11] op_sel_hi:[1,0]
  v_cvt_pk_bf16_f32 v128, v128, v129
  v_cvt_pk_bf16_f32 v228, v228, v229
  v_cvt_pk_bf16_f32 v129, v130, v131
  v_cvt_pk_bf16_f32 v229, v230, v231
  v_cvt_pk_bf16_f32 v130, v132, v133
  v_cvt_pk_bf16_f32 v230, v232, v233
  v_cvt_pk_bf16_f32 v131, v134, v135
  v_cvt_pk_bf16_f32 v231, v234, v235
  v_cvt_pk_bf16_f32 v132, v136, v137
  v_cvt_pk_bf16_f32 v232, v236, v237
  v_cvt_pk_bf16_f32 v133, v138, v139
  v_cvt_pk_bf16_f32 v233, v238, v239
  v_cvt_pk_bf16_f32 v134, v140, v141
  v_cvt_pk_bf16_f32 v234, v240, v241
  v_cvt_pk_bf16_f32 v135, v142, v143
  v_cvt_pk_bf16_f32 v235, v242, v243
  v_accvgpr_read_b32 v11, a0
  v_xor_b32 v12, 0, v11
  ds_write_b64 v12, v[128:129]
  v_xor_b32 v12, 16, v11
  ds_write_b64 v12, v[130:131]
  v_xor_b32 v12, 32, v11
  ds_write_b64 v12, v[132:133]
  v_xor_b32 v12, 48, v11
  ds_write_b64 v12, v[134:135]
  v_xor_b32 v12, 64, v11
  ds_write_b64 v12, v[228:229]
  v_xor_b32 v12, 80, v11
  ds_write_b64 v12, v[230:231]
  v_xor_b32 v12, 96, v11
  ds_write_b64 v12, v[232:233]
  v_xor_b32 v12, 112, v11
  ds_write_b64 v12, v[234:235]
  s_waitcnt vmcnt(3)
  s_waitcnt lgkmcnt(0)
  s_barrier
  s_cmp_lt_u32 s78, 2
  s_cbranch_scc1 L_kvs_5
  v_accvgpr_read_b32 v8, a2
  v_accvgpr_read_b32 v9, a3
  v_accvgpr_read_b32 v10, a4
  v_accvgpr_read_b32 v11, a5
  ds_read_b64_tr_b16 v[192:193], v8 offset:0
  ds_read_b64_tr_b16 v[194:195], v9 offset:512
  ds_read_b64_tr_b16 v[196:197], v10 offset:0
  ds_read_b64_tr_b16 v[198:199], v11 offset:256
  ds_read_b64_tr_b16 v[200:201], v8 offset:2048
  ds_read_b64_tr_b16 v[202:203], v9 offset:2560
  ds_read_b64_tr_b16 v[204:205], v10 offset:1024
  ds_read_b64_tr_b16 v[206:207], v11 offset:1280
  s_waitcnt lgkmcnt(4)
  v_mfma_f32_32x32x16_bf16 v[128:143], v[192:195], v[196:199], 0
  ds_read_b64_tr_b16 v[192:193], v8 offset:4096
  ds_read_b64_tr_b16 v[194:195], v9 offset:4608
  ds_read_b64_tr_b16 v[196:197], v10 offset:2048
  ds_read_b64_tr_b16 v[198:199], v11 offset:2304
  s_waitcnt lgkmcnt(4)
  v_mfma_f32_32x32x16_bf16 v[128:143], v[200:203], v[204:207], v[128:143]
  ds_read_b64_tr_b16 v[200:201], v8 offset:6144
  ds_read_b64_tr_b16 v[202:203], v9 offset:6656
  ds_read_b64_tr_b16 v[204:205], v10 offset:3072
  ds_read_b64_tr_b16 v[206:207], v11 offset:3328
  s_waitcnt lgkmcnt(4)
  v_mfma_f32_32x32x16_bf16 v[128:143], v[192:195], v[196:199], v[128:143]
  ds_read_b64_tr_b16 v[192:193], v8 offset:8192
  ds_read_b64_tr_b16 v[194:195], v9 offset:8704
  ds_read_b64_tr_b16 v[196:197], v10 offset:4096
  ds_read_b64_tr_b16 v[198:199], v11 offset:4352
  s_waitcnt lgkmcnt(4)
  v_mfma_f32_32x32x16_bf16 v[128:143], v[200:203], v[204:207], v[128:143]
  ds_read_b64_tr_b16 v[200:201], v8 offset:10240
  ds_read_b64_tr_b16 v[202:203], v9 offset:10752
  ds_read_b64_tr_b16 v[204:205], v10 offset:5120
  ds_read_b64_tr_b16 v[206:207], v11 offset:5376
  s_waitcnt lgkmcnt(4)
  v_mfma_f32_32x32x16_bf16 v[128:143], v[192:195], v[196:199], v[128:143]
  ds_read_b64_tr_b16 v[192:193], v8 offset:12288
  ds_read_b64_tr_b16 v[194:195], v9 offset:12800
  ds_read_b64_tr_b16 v[196:197], v10 offset:6144
  ds_read_b64_tr_b16 v[198:199], v11 offset:6400
  s_waitcnt lgkmcnt(4)
  v_mfma_f32_32x32x16_bf16 v[128:143], v[200:203], v[204:207], v[128:143]
  ds_read_b64_tr_b16 v[200:201], v8 offset:14336
  ds_read_b64_tr_b16 v[202:203], v9 offset:14848
  ds_read_b64_tr_b16 v[204:205], v10 offset:7168
  ds_read_b64_tr_b16 v[206:207], v11 offset:7424
  s_waitcnt lgkmcnt(4)
  v_mfma_f32_32x32x16_bf16 v[128:143], v[192:195], v[196:199], v[128:143]
  s_waitcnt lgkmcnt(0)
  v_mfma_f32_32x32x16_bf16 v[128:143], v[200:203], v[204:207], v[128:143]
  s_nop 11
  v_cvt_pk_bf16_f32 v128, v128, v129
  v_cvt_pk_bf16_f32 v129, v130, v131
  v_cvt_pk_bf16_f32 v130, v132, v133
  v_cvt_pk_bf16_f32 v131, v134, v135
  v_cvt_pk_bf16_f32 v132, v136, v137
  v_cvt_pk_bf16_f32 v133, v138, v139
  v_cvt_pk_bf16_f32 v134, v140, v141
  v_cvt_pk_bf16_f32 v135, v142, v143
  s_lshl_b32 s82, s77, 4
  s_add_u32 s82, s82, s76
  s_lshl_b32 s82, s82, 1
  s_and_b32 s83, s78, 1
  s_add_u32 s82, s82, s83
  s_lshl_b32 s83, s82, 11
  s_add_u32 s83, s83, 2097152
  buffer_store_dwordx4 v[128:131], v2, s[36:39], s83 offen offset:0 sc1
  buffer_store_dwordx4 v[132:135], v2, s[36:39], s83 offen offset:1024 sc1
  s_lshl_b32 s92, s82, 8
  s_add_u32 s92, s92, 0
L_kvs_5:
  s_cmp_ge_u32 s77, 7
  s_cselect_b32 s93, 1, 0
  s_mul_i32 s82, s93, 7
  s_sub_u32 s94, s77, s82
  s_lshl_b32 s95, s76, 2
  s_lshl_b32 s82, s93, 1
  s_add_u32 s95, s95, s82
  v_add_u32 v249, 40960, v253
  v_lshrrev_b32 v7, 3, v1
  v_bfe_u32 v11, v1, 4, 1
  v_lshlrev_b32 v11, 2, v11
  v_and_b32 v12, 7, v1
  v_xor_b32 v11, v11, v12
  v_mul_u32_u24 v7, 896, v7
  v_lshl_add_u32 v250, v11, 4, v7
  s_mul_i32 s75, s78, 6144
  v_bfe_u32 v7, v1, 2, 2
  v_lshl_add_u32 v11, v3, 2, v7
  v_lshlrev_b32 v11, 7, v11
  v_bfe_u32 v12, v1, 4, 1
  v_lshl_add_u32 v11, v12, 5, v11
  v_and_b32 v12, 3, v1
  v_lshl_add_u32 v11, v12, 3, v11
  v_lshrrev_b32 v7, 1, v7
  v_lshlrev_b32 v7, 6, v7
  v_xor_b32 v11, v11, v7
  v_add_u32 v11, s75, v11
  v_add_u32 v251, 139264, v11
  v_xor_b32 v252, 64, v251
  v_lshrrev_b32 v7, 4, v1
  v_lshlrev_b32 v11, 2, v7
  v_and_b32 v12, 15, v1
  v_xor_b32 v11, v11, v12
  v_mul_u32_u24 v7, 3584, v7
  v_lshl_add_u32 v253, v11, 4, v7
  s_lshl_b32 s72, s78, 12
  s_mul_i32 s71, s78, 57344
  s_lshl_b32 s82, s77, 8
  s_add_u32 s71, s71, s82
  ds_read_b64_tr_b16 v[192:193], v249 offset:0
  ds_read_b64_tr_b16 v[194:195], v249 offset:256
  ds_read_b64_tr_b16 v[196:197], v249 offset:1024
  ds_read_b64_tr_b16 v[198:199], v249 offset:1280
  ds_read_b64_tr_b16 v[200:201], v249 offset:2048
  ds_read_b64_tr_b16 v[202:203], v249 offset:2304
  ds_read_b64_tr_b16 v[204:205], v249 offset:3072
  ds_read_b64_tr_b16 v[206:207], v249 offset:3328
  s_waitcnt lgkmcnt(6)
  v_mfma_f32_32x32x16_bf16 v[160:175], v[192:195], v[16:19], 0
  v_mfma_f32_32x32x16_bf16 v[176:191], v[192:195], v[208:211], 0
  ds_read_b64_tr_b16 v[192:193], v249 offset:4096
  ds_read_b64_tr_b16 v[194:195], v249 offset:4352
  s_waitcnt lgkmcnt(6)
  v_mfma_f32_32x32x16_bf16 v[160:175], v[196:199], v[20:23], v[160:175]
  v_mfma_f32_32x32x16_bf16 v[176:191], v[196:199], v[208:211], v[176:191]
  ds_read_b64_tr_b16 v[196:197], v249 offset:5120
  ds_read_b64_tr_b16 v[198:199], v249 offset:5376
  s_waitcnt lgkmcnt(6)
  v_mfma_f32_32x32x16_bf16 v[160:175], v[200:203], v[24:27], v[160:175]
  v_mfma_f32_32x32x16_bf16 v[176:191], v[200:203], v[208:211], v[176:191]
  ds_read_b64_tr_b16 v[200:201], v249 offset:6144
  ds_read_b64_tr_b16 v[202:203], v249 offset:6400
  s_waitcnt lgkmcnt(6)
  v_mfma_f32_32x32x16_bf16 v[160:175], v[204:207], v[28:31], v[160:175]
  v_mfma_f32_32x32x16_bf16 v[176:191], v[204:207], v[208:211], v[176:191]
  ds_read_b64_tr_b16 v[204:205], v249 offset:7168
  ds_read_b64_tr_b16 v[206:207], v249 offset:7424
  s_waitcnt lgkmcnt(6)
  v_mfma_f32_32x32x16_bf16 v[160:175], v[192:195], v[32:35], v[160:175]
  v_mfma_f32_32x32x16_bf16 v[176:191], v[192:195], v[208:211], v[176:191]
  ds_read_b64_tr_b16 v[192:193], v249 offset:8192
  ds_read_b64_tr_b16 v[194:195], v249 offset:8448
  s_waitcnt lgkmcnt(6)
  v_mfma_f32_32x32x16_bf16 v[160:175], v[196:199], v[36:39], v[160:175]
  v_mfma_f32_32x32x16_bf16 v[176:191], v[196:199], v[208:211], v[176:191]
  ds_read_b64_tr_b16 v[196:197], v249 offset:9216
  ds_read_b64_tr_b16 v[198:199], v249 offset:9472
  s_waitcnt lgkmcnt(6)
  v_mfma_f32_32x32x16_bf16 v[160:175], v[200:203], v[40:43], v[160:175]
  v_mfma_f32_32x32x16_bf16 v[176:191], v[200:203], v[208:211], v[176:191]
  s_cmp_lt_u32 s78, 2
  s_cbranch_scc1 L_kf_6
  s_waitcnt vmcnt(0)
  v_mov_b32 v14, s97
  v_mov_b32 v15, s96
  v_mov_b32 v13, 0
  s_mov_b64 s[100:101], exec
  s_mov_b64 exec, 1
  buffer_store_dwordx2 v[14:15], v13, s[36:39], s92 offen sc1
  s_mov_b64 exec, s[100:101]
L_kf_6:
  ds_read_b64_tr_b16 v[200:201], v249 offset:10240
  ds_read_b64_tr_b16 v[202:203], v249 offset:10496
  s_waitcnt lgkmcnt(6)
  v_mfma_f32_32x32x16_bf16 v[160:175], v[204:207], v[44:47], v[160:175]
  v_mfma_f32_32x32x16_bf16 v[176:191], v[204:207], v[208:211], v[176:191]
  ds_read_b64_tr_b16 v[204:205], v249 offset:11264
  ds_read_b64_tr_b16 v[206:207], v249 offset:11520
  s_waitcnt lgkmcnt(6)
  v_mfma_f32_32x32x16_bf16 v[160:175], v[192:195], v[48:51], v[160:175]
  v_mfma_f32_32x32x16_bf16 v[176:191], v[192:195], v[208:211], v[176:191]
  s_mul_i32 s82, s76, 14
  s_add_u32 s82, s82, s77
  s_mul_i32 s83, s82, 147
  s_lshr_b32 s83, s83, 10
  s_mul_i32 s84, s83, 7
  s_sub_u32 s84, s82, s84
  s_lshl_b32 s83, s83, 2
  s_add_u32 s83, s83, s78
  s_mul_i32 s73, s83, 14
  s_lshl_b32 s81, s84, 1
  s_add_u32 s73, s73, s81
  s_lshl_b32 s73, s73, 10
  s_add_u32 s73, s73, 16777216
  s_mul_i32 s83, s83, 14336
  s_lshl_b32 s84, s84, 7
  s_add_u32 s83, s83, s84
  s_cmp_ge_u32 s82, 196
  s_cselect_b32 s84, 1, 0
  s_cmp_ge_u32 s77, 14
  s_cselect_b32 s84, 1, s84
  s_lshl_b32 s84, s84, 30
  s_add_u32 s73, s73, s84
  s_add_u32 s83, s83, s84
  s_lshl_b32 s84, s78, 11
  s_add_u32 m0, s84, 32768
  s_add_u32 s81, s83, 0
  buffer_load_dwordx4 v250, s[28:31], s81 offen lds
  s_add_u32 m0, s84, 33792
  s_add_u32 s81, s83, 7168
  buffer_load_dwordx4 v250, s[28:31], s81 offen lds
  ds_read_b64_tr_b16 v[192:193], v249 offset:12288
  ds_read_b64_tr_b16 v[194:195], v249 offset:12544
  s_waitcnt lgkmcnt(6)
  v_mfma_f32_32x32x16_bf16 v[160:175], v[196:199], v[52:55], v[160:175]
  v_mfma_f32_32x32x16_bf16 v[176:191], v[196:199], v[208:211], v[176:191]
  s_mul_i32 s86, s78, 100352
  s_lshl_b32 s82, s94, 7
  s_add_u32 s86, s86, s82
  s_and_b32 s82, s94, 1
  s_mul_i32 s82, s82, 50176
  s_sub_u32 s87, s86, s82
  s_add_u32 s86, s86, s82
  s_mul_i32 s3, s78, 10240
  s_add_u32 s82, s86, 0
  s_add_u32 m0, s3, 73728
  s_add_u32 s81, s82, 0
  buffer_load_dwordx4 v250, s[20:23], s81 offen lds
  s_add_u32 m0, s3, 74752
  s_add_u32 s81, s82, 7168
  buffer_load_dwordx4 v250, s[20:23], s81 offen lds
  ds_read_b64_tr_b16 v[196:197], v249 offset:13312
  ds_read_b64_tr_b16 v[198:199], v249 offset:13568
  s_waitcnt lgkmcnt(6)
  v_mfma_f32_32x32x16_bf16 v[160:175], v[200:203], v[56:59], v[160:175]
  v_mfma_f32_32x32x16_bf16 v[176:191], v[200:203], v[208:211], v[176:191]
  ds_read_b64_tr_b16 v[200:201], v249 offset:14336
  ds_read_b64_tr_b16 v[202:203], v249 offset:14592
  s_waitcnt lgkmcnt(6)
  v_mfma_f32_32x32x16_bf16 v[160:175], v[204:207], v[60:63], v[160:175]
  v_mfma_f32_32x32x16_bf16 v[176:191], v[204:207], v[208:211], v[176:191]
  s_add_u32 s82, s86, 14336
  s_add_u32 m0, s3, 75776
  s_add_u32 s81, s82, 0
  buffer_load_dwordx4 v250, s[20:23], s81 offen lds
  s_add_u32 m0, s3, 76800
  s_add_u32 s81, s82, 7168
  buffer_load_dwordx4 v250, s[20:23], s81 offen lds
  ds_read_b64_tr_b16 v[204:205], v249 offset:15360
  ds_read_b64_tr_b16 v[206:207], v249 offset:15616
  s_waitcnt lgkmcnt(6)
  v_mfma_f32_32x32x16_bf16 v[160:175], v[192:195], v[64:67], v[160:175]
  v_mfma_f32_32x32x16_bf16 v[176:191], v[192:195], v[208:211], v[176:191]
  ds_read_b64_tr_b16 v[192:193], v249 offset:16384
  ds_read_b64_tr_b16 v[194:195], v249 offset:16640
  s_waitcnt lgkmcnt(6)
  v_mfma_f32_32x32x16_bf16 v[160:175], v[196:199], v[68:71], v[160:175]
  v_mfma_f32_32x32x16_bf16 v[176:191], v[196:199], v[208:211], v[176:191]
  s_add_u32 s82, s86, 25088
  s_add_u32 m0, s3, 77824
  s_add_u32 s81, s82, 0
  buffer_load_dwordx4 v250, s[20:23], s81 offen lds
  s_add_u32 m0, s3, 78848
  s_add_u32 s81, s82, 7168
  buffer_load_dwordx4 v250, s[20:23], s81 offen lds
  ds_read_b64_tr_b16 v[196:197], v249 offset:17408
  ds_read_b64_tr_b16 v[198:199], v249 offset:17664
  s_waitcnt lgkmcnt(6)
  v_mfma_f32_32x32x16_bf16 v[160:175], v[200:203], v[72:75], v[160:175]
  v_mfma_f32_32x32x16_bf16 v[176:191], v[200:203], v[208:211], v[176:191]
  ds_read_b64_tr_b16 v[200:201], v249 offset:18432
  ds_read_b64_tr_b16 v[202:203], v249 offset:18688
  s_waitcnt lgkmcnt(6)
  v_mfma_f32_32x32x16_bf16 v[160:175], v[204:207], v[76:79], v[160:175]
  v_mfma_f32_32x32x16_bf16 v[176:191], v[204:207], v[208:211], v[176:191]
  s_add_u32 s82, s86, 39424
  s_add_u32 m0, s3, 79872
  s_add_u32 s81, s82, 0
  buffer_load_dwordx4 v250, s[20:23], s81 offen lds
  s_add_u32 m0, s3, 80896
  s_add_u32 s81, s82, 7168
  buffer_load_dwordx4 v250, s[20:23], s81 offen lds
  ds_read_b64_tr_b16 v[204:205], v249 offset:19456
  ds_read_b64_tr_b16 v[206:207], v249 offset:19712
  s_waitcnt lgkmcnt(6)
  v_mfma_f32_32x32x16_bf16 v[160:175], v[192:195], v[80:83], v[160:175]
  v_mfma_f32_32x32x16_bf16 v[176:191], v[192:195], v[208:211], v[176:191]
  ds_read_b64_tr_b16 v[192:193], v249 offset:20480
  ds_read_b64_tr_b16 v[194:195], v249 offset:20736
  s_waitcnt lgkmcnt(6)
  v_mfma_f32_32x32x16_bf16 v[160:175], v[196:199], v[84:87], v[160:175]
  v_mfma_f32_32x32x16_bf16 v[176:191], v[196:199], v[208:211], v[176:191]
  s_add_u32 s82, s87, 50176
  s_add_u32 m0, s3, 81920
  s_add_u32 s81, s82, 0
  buffer_load_dwordx4 v250, s[20:23], s81 offen lds
  s_add_u32 m0, s3, 82944
  s_add_u32 s81, s82, 7168
  buffer_load_dwordx4 v250, s[20:23], s81 offen lds
  ds_read_b64_tr_b16 v[196:197], v249 offset:21504
  ds_read_b64_tr_b16 v[198:199], v249 offset:21760
  s_waitcnt lgkmcnt(6)
  v_mfma_f32_32x32x16_bf16 v[160:175], v[200:203], v[88:91], v[160:175]
  v_mfma_f32_32x32x16_bf16 v[176:191], v[200:203], v[208:211], v[176:191]
  ds_read_b64_tr_b16 v[200:201], v249 offset:22528
  ds_read_b64_tr_b16 v[202:203], v249 offset:22784
  s_waitcnt lgkmcnt(6)
  v_mfma_f32_32x32x16_bf16 v[160:175], v[204:207], v[92:95], v[160:175]
  v_mfma_f32_32x32x16_bf16 v[176:191], v[204:207], v[208:211], v[176:191]
  s_add_u32 s82, s87, 64512
  s_add_u32 m0, s75, 139264
  s_add_u32 s81, s82, 0
  buffer_load_dwordx4 v250, s[20:23], s81 offen lds
  s_add_u32 m0, s75, 140288
  s_add_u32 s81, s82, 7168
  buffer_load_dwordx4 v250, s[20:23], s81 offen lds
  ds_read_b64_tr_b16 v[204:205], v249 offset:23552
  ds_read_b64_tr_b16 v[206:207], v249 offset:23808
  s_waitcnt lgkmcnt(6)
  v_mfma_f32_32x32x16_bf16 v[160:175], v[192:195], v[96:99], v[160:175]
  v_mfma_f32_32x32x16_bf16 v[176:191], v[192:195], v[208:211], v[176:191]
  ds_read_b64_tr_b16 v[192:193], v249 offset:24576
  ds_read_b64_tr_b16 v[194:195], v249 offset:24832
  s_waitcnt lgkmcnt(6)
  v_mfma_f32_32x32x16_bf16 v[160:175], v[196:199], v[100:103], v[160:175]
  v_mfma_f32_32x32x16_bf16 v[176:191], v[196:199], v[208:211], v[176:191]
  s_add_u32 s82, s87, 75264
  s_add_u32 m0, s75, 141312
  s_add_u32 s81, s82, 0
  buffer_load_dwordx4 v250, s[20:23], s81 offen lds
  s_add_u32 m0, s75, 142336
  s_add_u32 s81, s82, 7168
  buffer_load_dwordx4 v250, s[20:23], s81 offen lds
  ds_read_b64_tr_b16 v[196:197], v249 offset:25600
  ds_read_b64_tr_b16 v[198:199], v249 offset:25856
  s_waitcnt lgkmcnt(6)
  v_mfma_f32_32x32x16_bf16 v[160:175], v[200:203], v[104:107], v[160:175]
  v_mfma_f32_32x32x16_bf16 v[176:191], v[200:203], v[208:211], v[176:191]
  ds_read_b64_tr_b16 v[200:201], v249 offset:26624
  ds_read_b64_tr_b16 v[202:203], v249 offset:26880
  s_waitcnt lgkmcnt(6)
  v_mfma_f32_32x32x16_bf16 v[160:175], v[204:207], v[108:111], v[160:175]
  v_mfma_f32_32x32x16_bf16 v[176:191], v[204:207], v[208:211], v[176:191]
  s_add_u32 s82, s87, 89600
  s_add_u32 m0, s75, 143360
  s_add_u32 s81, s82, 0
  buffer_load_dwordx4 v250, s[20:23], s81 offen lds
  s_add_u32 m0, s75, 144384
  s_add_u32 s81, s82, 7168
  buffer_load_dwordx4 v250, s[20:23], s81 offen lds
  ds_read_b64_tr_b16 v[204:205], v249 offset:27648
  ds_read_b64_tr_b16 v[206:207], v249 offset:27904
  s_waitcnt lgkmcnt(6)
  v_mfma_f32_32x32x16_bf16 v[160:175], v[192:195], v[112:115], v[160:175]
  v_mfma_f32_32x32x16_bf16 v[176:191], v[192:195], v[208:211], v[176:191]
  s_waitcnt lgkmcnt(4)
  v_mfma_f32_32x32x16_bf16 v[160:175], v[196:199], v[116:119], v[160:175]
  v_mfma_f32_32x32x16_bf16 v[176:191], v[196:199], v[208:211], v[176:191]
  s_waitcnt lgkmcnt(2)
  v_mfma_f32_32x32x16_bf16 v[160:175], v[200:203], v[120:123], v[160:175]
  v_mfma_f32_32x32x16_bf16 v[176:191], v[200:203], v[208:211], v[176:191]
  s_waitcnt lgkmcnt(0)
  v_mfma_f32_32x32x16_bf16 v[160:175], v[204:207], v[124:127], v[160:175]
  v_mfma_f32_32x32x16_bf16 v[176:191], v[204:207], v[208:211], v[176:191]
  v_sub_f32 v8, 0, v244
  s_nop 10
  v_pk_fma_f32 v[160:161], v[8:9], v[176:177], v[160:161] op_sel_hi:[0,1,1]
  v_pk_fma_f32 v[162:163], v[8:9], v[178:179], v[162:163] op_sel_hi:[0,1,1]
  v_pk_fma_f32 v[164:165], v[8:9], v[180:181], v[164:165] op_sel_hi:[0,1,1]
  v_pk_fma_f32 v[166:167], v[8:9], v[182:183], v[166:167] op_sel_hi:[0,1,1]
  v_pk_fma_f32 v[168:169], v[8:9], v[184:185], v[168:169] op_sel_hi:[0,1,1]
  v_pk_fma_f32 v[170:171], v[8:9], v[186:187], v[170:171] op_sel_hi:[0,1,1]
  v_pk_fma_f32 v[172:173], v[8:9], v[188:189], v[172:173] op_sel_hi:[0,1,1]
  v_pk_fma_f32 v[174:175], v[8:9], v[190:191], v[174:175] op_sel_hi:[0,1,1]
  v_pk_mul_f32 v[160:161], v[160:161], v[244:245] op_sel:[0,1] op_sel_hi:[1,1]
  v_pk_mul_f32 v[162:163], v[162:163], v[244:245] op_sel:[0,1] op_sel_hi:[1,1]
  v_pk_mul_f32 v[164:165], v[164:165], v[244:245] op_sel:[0,1] op_sel_hi:[1,1]
  v_pk_mul_f32 v[166:167], v[166:167], v[244:245] op_sel:[0,1] op_sel_hi:[1,1]
  v_pk_mul_f32 v[168:169], v[168:169], v[244:245] op_sel:[0,1] op_sel_hi:[1,1]
  v_pk_mul_f32 v[170:171], v[170:171], v[244:245] op_sel:[0,1] op_sel_hi:[1,1]
  v_pk_mul_f32 v[172:173], v[172:173], v[244:245] op_sel:[0,1] op_sel_hi:[1,1]
  v_pk_mul_f32 v[174:175], v[174:175], v[244:245] op_sel:[0,1] op_sel_hi:[1,1]
  s_mul_i32 s83, s78, 10240
  v_bfe_u32 v7, v1, 2, 2
  v_lshl_add_u32 v11, v3, 2, v7
  v_lshlrev_b32 v11, 7, v11
  v_bfe_u32 v12, v1, 4, 1
  v_lshl_add_u32 v11, v12, 5, v11
  v_and_b32 v12, 3, v1
  v_lshl_add_u32 v11, v12, 3, v11
  v_lshrrev_b32 v7, 1, v7
  v_lshlrev_b32 v7, 6, v7
  v_xor_b32 v11, v11, v7
  v_add_u32 v11, s83, v11
  v_add_u32 v246, 73728, v11
  v_xor_b32 v247, 64, v246
  s_waitcnt vmcnt(14)
  ds_read_b64_tr_b16 a[192:193], v246 offset:0
  ds_read_b64_tr_b16 a[194:195], v246 offset:1024
  ds_read_b64_tr_b16 a[196:197], v247 offset:0
  ds_read_b64_tr_b16 a[198:199], v247 offset:1024
  s_lshl_b32 s83, s78, 11
  v_bfe_u32 v7, v1, 2, 2
  v_lshl_add_u32 v11, v3, 2, v7
  v_lshlrev_b32 v11, 7, v11
  v_bfe_u32 v12, v1, 4, 1
  v_lshl_add_u32 v11, v12, 5, v11
  v_and_b32 v12, 3, v1
  v_lshl_add_u32 v11, v12, 3, v11
  v_lshrrev_b32 v7, 1, v7
  v_lshlrev_b32 v7, 6, v7
  v_xor_b32 v11, v11, v7
  v_add_u32 v11, s83, v11
  v_add_u32 v136, 32768, v11
  v_xor_b32 v137, 64, v136
  ds_read_b64_tr_b16 v[128:129], v136 offset:0
  ds_read_b64_tr_b16 v[130:131], v136 offset:1024
  ds_read_b64_tr_b16 v[132:133], v137 offset:0
  ds_read_b64_tr_b16 v[134:135], v137 offset:1024
  s_waitcnt lgkmcnt(0)
  buffer_store_dwordx4 v[128:131], v2, s[36:39], s73 offen offset:0 sc1
  buffer_store_dwordx4 v[132:135], v2, s[36:39], s73 offen offset:1024 sc1
  v_cvt_pk_bf16_f32 v200, v160, v161
  v_cvt_pk_bf16_f32 v201, v162, v163
  v_cvt_pk_bf16_f32 v202, v164, v165
  v_cvt_pk_bf16_f32 v203, v166, v167
  v_cvt_pk_bf16_f32 v204, v168, v169
  v_cvt_pk_bf16_f32 v205, v170, v171
  v_cvt_pk_bf16_f32 v206, v172, v173
  v_cvt_pk_bf16_f32 v207, v174, v175
  v_and_b32 v206, v4, v206
  v_and_b32 v207, v4, v207
  v_mfma_f32_32x32x16_bf16 v[176:191], v[212:215], v[200:203], 0
  s_nop 0
  v_mfma_f32_32x32x16_bf16 v[176:191], v[216:219], v[204:207], v[176:191]
  s_waitcnt vmcnt(14)
  ds_read_b64_tr_b16 a[200:201], v246 offset:2048
  ds_read_b64_tr_b16 a[202:203], v246 offset:3072
  ds_read_b64_tr_b16 a[204:205], v247 offset:2048
  ds_read_b64_tr_b16 a[206:207], v247 offset:3072
  s_waitcnt vmcnt(12)
  ds_read_b64_tr_b16 a[208:209], v246 offset:4096
  ds_read_b64_tr_b16 a[210:211], v246 offset:5120
  ds_read_b64_tr_b16 a[212:213], v247 offset:4096
  ds_read_b64_tr_b16 a[214:215], v247 offset:5120
  s_nop 1
  v_max3_f32 v8, v176, v177, v178
  v_min3_f32 v9, v176, v177, v178
  v_max3_f32 v8, v8, v179, v180
  v_min3_f32 v9, v9, v179, v180
  v_max3_f32 v8, v8, v181, v182
  v_min3_f32 v9, v9, v181, v182
  v_max3_f32 v8, v8, v183, v184
  v_min3_f32 v9, v9, v183, v184
  v_max3_f32 v8, v8, v185, v186
  v_min3_f32 v9, v9, v185, v186
  v_max_f32 v8, v8, v187
  v_min_f32 v9, v9, v187
  v_max3_f32 v10, v188, v189, v190
  v_min3_f32 v11, v188, v189, v190
  v_max_f32 v10, v10, v191
  v_min_f32 v11, v11, v191
  v_add_f32 v10, v10, v5
  v_add_f32 v11, v11, v6
  v_max_f32 v8, v8, v10
  v_min_f32 v9, v9, v11
  s_waitcnt vmcnt(10)
  ds_read_b64_tr_b16 a[216:217], v246 offset:6144
  ds_read_b64_tr_b16 a[218:219], v246 offset:7168
  ds_read_b64_tr_b16 a[220:221], v247 offset:6144
  ds_read_b64_tr_b16 a[222:223], v247 offset:7168
  s_waitcnt vmcnt(8)
  ds_read_b64_tr_b16 a[224:225], v246 offset:8192
  ds_read_b64_tr_b16 a[226:227], v246 offset:9216
  ds_read_b64_tr_b16 a[228:229], v247 offset:8192
  s_waitcnt lgkmcnt(14)
  ds_read_b64_tr_b16 a[230:231], v247 offset:9216
  v_mov_b32 v10, v8
  s_nop 1
  v_permlane32_swap_b32 v8, v10
  v_max_f32 v8, v8, v10
  v_mov_b32 v11, v9
  s_nop 1
  v_permlane32_swap_b32 v9, v11
  v_min_f32 v9, v9, v11
  s_mov_b32 s85, 0x3fb8aa3b
  s_mov_b32 s5, 0xbfb8aa3b
  v_mul_f32 v8, s5, v8
  v_mul_f32 v9, s85, v9
  v_add_f32 v10, v8, v5
  v_add_f32 v11, v9, v5
  s_waitcnt vmcnt(6)
  s_waitcnt lgkmcnt(14)
  ds_read_b64_tr_b16 a[232:233], v251 offset:0
  s_waitcnt lgkmcnt(14)
  ds_read_b64_tr_b16 a[234:235], v251 offset:1024
  s_waitcnt lgkmcnt(14)
  ds_read_b64_tr_b16 a[236:237], v252 offset:0
  s_waitcnt lgkmcnt(14)
  ds_read_b64_tr_b16 a[238:239], v252 offset:1024
  s_waitcnt vmcnt(4)
  s_waitcnt lgkmcnt(14)
  ds_read_b64_tr_b16 a[240:241], v251 offset:2048
  s_waitcnt lgkmcnt(14)
  ds_read_b64_tr_b16 a[242:243], v251 offset:3072
  s_waitcnt lgkmcnt(14)
  ds_read_b64_tr_b16 a[244:245], v252 offset:2048
  s_waitcnt lgkmcnt(14)
  ds_read_b64_tr_b16 a[246:247], v252 offset:3072
  v_fma_f32 v160, v176, s85, v8
  v_fma_f32 v228, v176, s5, v9
  v_fma_f32 v161, v177, s85, v8
  v_fma_f32 v229, v177, s5, v9
  v_fma_f32 v162, v178, s85, v8
  v_fma_f32 v230, v178, s5, v9
  v_fma_f32 v163, v179, s85, v8
  v_fma_f32 v231, v179, s5, v9
  s_waitcnt vmcnt(2)
  s_waitcnt lgkmcnt(14)
  ds_read_b64_tr_b16 a[248:249], v251 offset:4096
  s_waitcnt lgkmcnt(14)
  ds_read_b64_tr_b16 a[250:251], v251 offset:5120
  s_waitcnt lgkmcnt(14)
  ds_read_b64_tr_b16 a[252:253], v252 offset:4096
  s_waitcnt lgkmcnt(14)
  ds_read_b64_tr_b16 a[254:255], v252 offset:5120
  v_fma_f32 v164, v180, s85, v8
  v_fma_f32 v232, v180, s5, v9
  v_fma_f32 v165, v181, s85, v8
  v_fma_f32 v233, v181, s5, v9
  v_fma_f32 v166, v182, s85, v8
  v_fma_f32 v234, v182, s5, v9
  v_fma_f32 v167, v183, s85, v8
  v_fma_f32 v235, v183, s5, v9
  s_waitcnt lgkmcnt(0)
  s_waitcnt vmcnt(0)
  s_cmp_lg_u32 s78, 0
  s_cbranch_scc1 L_w0_7
  v_and_b32 v13, 31, v1
  s_lshl_b32 s82, s77, 5
  v_add_u32 v12, s82, v13
  v_lshrrev_b32 v15, 1, v13
  v_lshlrev_b32 v15, 5, v15
  v_and_b32 v13, 1, v13
  s_lshl_b32 s82, s76, 1
  v_add3_u32 v15, v15, v13, s82
  v_sub_u32 v15, v15, v12
  v_not_b32 v13, v4
  v_and_b32 v15, v15, v13
  v_add_u32 v12, v12, v15
  v_lshlrev_b32 v12, 8, v12
  s_mov_b32 s92, 0
  s_mov_b32 s88, 0
L_poll_8:
  buffer_load_dwordx2 v[14:15], v12, s[36:39], s92 offen sc1
  s_waitcnt vmcnt(0)
  v_and_b32 v13, 0xfffffff8, v14
  v_xor_b32 v13, s80, v13
  v_xor_b32 v15, s96, v15
  v_or_b32 v13, v13, v15
  v_cmp_ne_u32 vcc, 0, v13
  s_add_u32 s88, s88, 1
  s_cmp_ge_u32 s88, 0x100000
  s_cbranch_scc1 L_pd_9
  s_cmp_lg_u64 vcc, 0
  s_cbranch_scc1 L_poll_8
L_pd_9:
  s_and_b32 s82, s97, 7
  v_and_b32 v15, 7, v14
  v_or_b32 v15, v15, v4
  s_nop 0
  v_cmp_ne_u32 vcc, s82, v15
  s_nop 1
  s_cmp_eq_u32 vcc_hi, 0
  s_cselect_b32 s79, 1, 0
  v_mov_b32 v14, s79
  v_mov_b32 v15, 135168
  ds_write_b32 v15, v14
  s_waitcnt lgkmcnt(0)
L_w0_7:
  s_barrier
  s_cmp_lg_u32 s78, 0
  s_cbranch_scc1 L_w0_10
  s_mul_i32 s82, s76, 14
  s_add_u32 s82, s82, s77
  s_lshl_b32 s82, s82, 8
  s_add_u32 s82, s82, 1572864
  s_cmp_ge_u32 s77, 14
  s_cselect_b32 s83, 0x40000000, 0
  s_add_u32 s82, s82, s83
  v_mov_b32 v14, s97
  v_mov_b32 v15, s96
  v_mov_b32 v13, 0
  s_mov_b64 s[100:101], exec
  s_mov_b64 exec, 1
  buffer_store_dwordx2 v[14:15], v13, s[36:39], s82 offen sc1
  s_mov_b64 exec, s[100:101]
L_w0_10:
  v_mov_b32 v15, 135168
  ds_read_b32 v14, v15
  s_waitcnt lgkmcnt(0)
  v_readfirstlane_b32 s79, v14
  s_lshl_b32 s89, s77, 16
  s_mov_b32 s3, s76
  s_and_b32 s82, s78, 1
  s_lshl_b32 s82, s82, 11
  s_add_u32 s89, s89, s82
  s_lshr_b32 s82, s78, 1
  s_lshl_b32 s82, s82, 10
  s_add_u32 s89, s89, s82
  s_add_u32 s89, s89, 2097152
  s_lshl_b32 s81, s3, 12
  s_add_u32 s81, s81, s89
  s_add_u32 s3, s3, 1
  s_and_b32 s3, s3, 15
  buffer_load_dwordx4 v[16:19], v2, s[36:39], s81 offen sc1
  s_lshl_b32 s81, s3, 12
  s_add_u32 s81, s81, s89
  s_add_u32 s3, s3, 1
  s_and_b32 s3, s3, 15
  buffer_load_dwordx4 v[20:23], v2, s[36:39], s81 offen sc1
  s_lshl_b32 s81, s3, 12
  s_add_u32 s81, s81, s89
  s_add_u32 s3, s3, 1
  s_and_b32 s3, s3, 15
  buffer_load_dwordx4 v[24:27], v2, s[36:39], s81 offen sc1
  s_lshl_b32 s81, s3, 12
  s_add_u32 s81, s81, s89
  s_add_u32 s3, s3, 1
  s_and_b32 s3, s3, 15
  buffer_load_dwordx4 v[28:31], v2, s[36:39], s81 offen sc1
  s_lshl_b32 s81, s3, 12
  s_add_u32 s81, s81, s89
  s_add_u32 s3, s3, 1
  s_and_b32 s3, s3, 15
  buffer_load_dwordx4 v[32:35], v2, s[36:39], s81 offen sc1
  s_lshl_b32 s81, s3, 12
  s_add_u32 s81, s81, s89
  s_add_u32 s3, s3, 1
  s_and_b32 s3, s3, 15
  buffer_load_dwordx4 v[36:39], v2, s[36:39], s81 offen sc1
  s_lshl_b32 s81, s3, 12
  s_add_u32 s81, s81, s89
  s_add_u32 s3, s3, 1
  s_and_b32 s3, s3, 15
  buffer_load_dwordx4 v[40:43], v2, s[36:39], s81 offen sc1
  s_lshl_b32 s81, s3, 12
  s_add_u32 s81, s81, s89
  s_add_u32 s3, s3, 1
  s_and_b32 s3, s3, 15
  buffer_load_dwordx4 v[44:47], v2, s[36:39], s81 offen sc1
  v_fma_f32 v168, v184, s85, v8
  v_fma_f32 v236, v184, s5, v9
  v_fma_f32 v169, v185, s85, v8
  v_fma_f32 v237, v185, s5, v9
  v_fma_f32 v170, v186, s85, v8
  v_fma_f32 v238, v186, s5, v9
  v_fma_f32 v171, v187, s85, v8
  v_fma_f32 v239, v187, s5, v9
  s_lshl_b32 s81, s3, 12
  s_add_u32 s81, s81, s89
  s_add_u32 s3, s3, 1
  s_and_b32 s3, s3, 15
  buffer_load_dwordx4 v[48:51], v2, s[36:39], s81 offen sc1
  v_fma_f32 v172, v188, s85, v10
  v_fma_f32 v240, v188, s5, v11
  v_fma_f32 v173, v189, s85, v10
  v_fma_f32 v241, v189, s5, v11
  v_fma_f32 v174, v190, s85, v10
  v_fma_f32 v242, v190, s5, v11
  v_fma_f32 v175, v191, s85, v10
  v_fma_f32 v243, v191, s5, v11
  s_lshl_b32 s81, s3, 12
  s_add_u32 s81, s81, s89
  s_add_u32 s3, s3, 1
  s_and_b32 s3, s3, 15
  buffer_load_dwordx4 v[52:55], v2, s[36:39], s81 offen sc1
  v_exp_f32 v160, v160
  v_exp_f32 v228, v228
  v_exp_f32 v161, v161
  v_exp_f32 v229, v229
  v_exp_f32 v162, v162
  v_exp_f32 v230, v230
  v_exp_f32 v163, v163
  v_exp_f32 v231, v231
  s_lshl_b32 s81, s3, 12
  s_add_u32 s81, s81, s89
  s_add_u32 s3, s3, 1
  s_and_b32 s3, s3, 15
  buffer_load_dwordx4 v[56:59], v2, s[36:39], s81 offen sc1
  v_exp_f32 v164, v164
  v_exp_f32 v232, v232
  v_exp_f32 v165, v165
  v_exp_f32 v233, v233
  v_exp_f32 v166, v166
  v_exp_f32 v234, v234
  v_exp_f32 v167, v167
  v_exp_f32 v235, v235
  s_lshl_b32 s81, s3, 12
  s_add_u32 s81, s81, s89
  s_add_u32 s3, s3, 1
  s_and_b32 s3, s3, 15
  buffer_load_dwordx4 v[60:63], v2, s[36:39], s81 offen sc1
  v_exp_f32 v168, v168
  v_exp_f32 v236, v236
  v_exp_f32 v169, v169
  v_exp_f32 v237, v237
  v_exp_f32 v170, v170
  v_exp_f32 v238, v238
  v_exp_f32 v171, v171
  v_exp_f32 v239, v239
  s_lshl_b32 s81, s3, 12
  s_add_u32 s81, s81, s89
  s_add_u32 s3, s3, 1
  s_and_b32 s3, s3, 15
  buffer_load_dwordx4 v[64:67], v2, s[36:39], s81 offen sc1
  v_exp_f32 v172, v172
  v_exp_f32 v240, v240
  v_exp_f32 v173, v173
  v_exp_f32 v241, v241
  v_exp_f32 v174, v174
  v_exp_f32 v242, v242
  v_exp_f32 v175, v175
  v_exp_f32 v243, v243
  s_lshl_b32 s81, s3, 12
  s_add_u32 s81, s81, s89
  s_add_u32 s3, s3, 1
  s_and_b32 s3, s3, 15
  buffer_load_dwordx4 v[68:71], v2, s[36:39], s81 offen sc1
  v_pk_add_f32 v[8:9], v[160:161], v[162:163]
  v_pk_add_f32 v[8:9], v[8:9], v[164:165]
  v_pk_add_f32 v[8:9], v[8:9], v[166:167]
  v_pk_add_f32 v[8:9], v[8:9], v[168:169]
  v_pk_add_f32 v[8:9], v[8:9], v[170:171]
  v_pk_add_f32 v[8:9], v[8:9], v[172:173]
  v_pk_add_f32 v[8:9], v[8:9], v[174:175]
  v_add_f32 v8, v8, v9
  s_lshl_b32 s81, s3, 12
  s_add_u32 s81, s81, s89
  s_add_u32 s3, s3, 1
  s_and_b32 s3, s3, 15
  buffer_load_dwordx4 v[72:75], v2, s[36:39], s81 offen sc1
  v_pk_add_f32 v[10:11], v[228:229], v[230:231]
  v_pk_add_f32 v[10:11], v[10:11], v[232:233]
  v_pk_add_f32 v[10:11], v[10:11], v[234:235]
  v_pk_add_f32 v[10:11], v[10:11], v[236:237]
  v_pk_add_f32 v[10:11], v[10:11], v[238:239]
  v_pk_add_f32 v[10:11], v[10:11], v[240:241]
  v_pk_add_f32 v[10:11], v[10:11], v[242:243]
  v_add_f32 v10, v10, v11
  s_lshl_b32 s81, s3, 12
  s_add_u32 s81, s81, s89
  s_add_u32 s3, s3, 1
  s_and_b32 s3, s3, 15
  buffer_load_dwordx4 v[76:79], v2, s[36:39], s81 offen sc1
  v_mov_b32 v9, v8
  s_nop 1
  v_permlane32_swap_b32 v8, v9
  v_add_f32 v8, v8, v9
  v_mov_b32 v11, v10
  s_nop 1
  v_permlane32_swap_b32 v10, v11
  v_add_f32 v10, v10, v11
  v_rcp_f32 v8, v8
  v_rcp_f32 v10, v10
  v_min_u32 v13, 11, v1
  v_lshrrev_b32 v12, 2, v13
  v_lshlrev_b32 v12, 18, v12
  v_and_b32 v13, 3, v13
  v_lshl_or_b32 v13, v13, 7, v12
  s_lshl_b32 s82, s76, 9
  s_add_u32 s82, s82, 262144
  buffer_load_dword a14, v13, s[36:39], s82 offen sc1
  v_pk_mul_f32 v[160:161], v[160:161], v[8:9] op_sel_hi:[1,0]
  v_pk_mul_f32 v[228:229], v[228:229], v[10:11] op_sel_hi:[1,0]
  v_pk_mul_f32 v[162:163], v[162:163], v[8:9] op_sel_hi:[1,0]
  v_pk_mul_f32 v[230:231], v[230:231], v[10:11] op_sel_hi:[1,0]
  v_pk_mul_f32 v[164:165], v[164:165], v[8:9] op_sel_hi:[1,0]
  v_pk_mul_f32 v[232:233], v[232:233], v[10:11] op_sel_hi:[1,0]
  v_pk_mul_f32 v[166:167], v[166:167], v[8:9] op_sel_hi:[1,0]
  v_pk_mul_f32 v[234:235], v[234:235], v[10:11] op_sel_hi:[1,0]
  v_pk_mul_f32 v[168:169], v[168:169], v[8:9] op_sel_hi:[1,0]
  v_pk_mul_f32 v[236:237], v[236:237], v[10:11] op_sel_hi:[1,0]
  v_pk_mul_f32 v[170:171], v[170:171], v[8:9] op_sel_hi:[1,0]
  v_pk_mul_f32 v[238:239], v[238:239], v[10:11] op_sel_hi:[1,0]
  v_pk_mul_f32 v[172:173], v[172:173], v[8:9] op_sel_hi:[1,0]
  v_pk_mul_f32 v[240:241], v[240:241], v[10:11] op_sel_hi:[1,0]
  v_pk_mul_f32 v[174:175], v[174:175], v[8:9] op_sel_hi:[1,0]
  v_pk_mul_f32 v[242:243], v[242:243], v[10:11] op_sel_hi:[1,0]
  v_cvt_pk_bf16_f32 v160, v160, v161
  v_cvt_pk_bf16_f32 v228, v228, v229
  v_cvt_pk_bf16_f32 v161, v162, v163
  v_cvt_pk_bf16_f32 v229, v230, v231
  v_cvt_pk_bf16_f32 v162, v164, v165
  v_cvt_pk_bf16_f32 v230, v232, v233
  v_cvt_pk_bf16_f32 v163, v166, v167
  v_cvt_pk_bf16_f32 v231, v234, v235
  v_cvt_pk_bf16_f32 v164, v168, v169
  v_cvt_pk_bf16_f32 v232, v236, v237
  v_cvt_pk_bf16_f32 v165, v170, v171
  v_cvt_pk_bf16_f32 v233, v238, v239
  v_cvt_pk_bf16_f32 v166, v172, v173
  v_cvt_pk_bf16_f32 v234, v240, v241
  v_cvt_pk_bf16_f32 v167, v174, v175
  v_cvt_pk_bf16_f32 v235, v242, v243
  v_mov_b32 v12, 0x3f80
  v_mov_b32 v13, 0x3f800000
  v_mov_b32 v80, 0
  v_mov_b32 v81, 0
  v_mov_b32 v82, 0
  v_mov_b32 v83, 0
  v_mov_b32 v84, 0
  v_mov_b32 v85, 0
  v_mov_b32 v86, 0
  v_mov_b32 v87, 0
  s_waitcnt vmcnt(16)
  v_dot2c_f32_bf16 v80, v16, v12
  v_dot2c_f32_bf16 v81, v16, v13
  v_dot2c_f32_bf16 v82, v17, v12
  v_dot2c_f32_bf16 v83, v17, v13
  v_dot2c_f32_bf16 v84, v18, v12
  v_dot2c_f32_bf16 v85, v18, v13
  v_dot2c_f32_bf16 v86, v19, v12
  v_dot2c_f32_bf16 v87, v19, v13
  s_waitcnt vmcnt(15)
  v_dot2c_f32_bf16 v80, v20, v12
  v_dot2c_f32_bf16 v81, v20, v13
  v_dot2c_f32_bf16 v82, v21, v12
  v_dot2c_f32_bf16 v83, v21, v13
  v_dot2c_f32_bf16 v84, v22, v12
  v_dot2c_f32_bf16 v85, v22, v13
  v_dot2c_f32_bf16 v86, v23, v12
  v_dot2c_f32_bf16 v87, v23, v13
  s_waitcnt vmcnt(14)
  v_dot2c_f32_bf16 v80, v24, v12
  v_dot2c_f32_bf16 v81, v24, v13
  v_dot2c_f32_bf16 v82, v25, v12
  v_dot2c_f32_bf16 v83, v25, v13
  v_dot2c_f32_bf16 v84, v26, v12
  v_dot2c_f32_bf16 v85, v26, v13
  v_dot2c_f32_bf16 v86, v27, v12
  v_dot2c_f32_bf16 v87, v27, v13
  s_waitcnt vmcnt(13)
  v_dot2c_f32_bf16 v80, v28, v12
  v_dot2c_f32_bf16 v81, v28, v13
  v_dot2c_f32_bf16 v82, v29, v12
  v_dot2c_f32_bf16 v83, v29, v13
  v_dot2c_f32_bf16 v84, v30, v12
  v_dot2c_f32_bf16 v85, v30, v13
  v_dot2c_f32_bf16 v86, v31, v12
  v_dot2c_f32_bf16 v87, v31, v13
  s_add_u32 s74, s71, 0
  s_add_u32 m0, s72, 0
  s_add_u32 s81, s74, 0
  buffer_load_dwordx4 v253, s[24:27], s81 offen lds
  s_waitcnt vmcnt(13)
  v_dot2c_f32_bf16 v80, v32, v12
  v_dot2c_f32_bf16 v81, v32, v13
  v_dot2c_f32_bf16 v82, v33, v12
  v_dot2c_f32_bf16 v83, v33, v13
  v_dot2c_f32_bf16 v84, v34, v12
  v_dot2c_f32_bf16 v85, v34, v13
  v_dot2c_f32_bf16 v86, v35, v12
  v_dot2c_f32_bf16 v87, v35, v13
  s_add_u32 m0, s72, 1024
  s_add_u32 s81, s74, 14336
  buffer_load_dwordx4 v253, s[24:27], s81 offen lds
  s_waitcnt vmcnt(13)
  v_dot2c_f32_bf16 v80, v36, v12
  v_dot2c_f32_bf16 v81, v36, v13
  v_dot2c_f32_bf16 v82, v37, v12
  v_dot2c_f32_bf16 v83, v37, v13
  v_dot2c_f32_bf16 v84, v38, v12
  v_dot2c_f32_bf16 v85, v38, v13
  v_dot2c_f32_bf16 v86, v39, v12
  v_dot2c_f32_bf16 v87, v39, v13
  s_add_u32 m0, s72, 2048
  s_add_u32 s81, s74, 28672
  buffer_load_dwordx4 v253, s[24:27], s81 offen lds
  s_waitcnt vmcnt(13)
  v_dot2c_f32_bf16 v80, v40, v12
  v_dot2c_f32_bf16 v81, v40, v13
  v_dot2c_f32_bf16 v82, v41, v12
  v_dot2c_f32_bf16 v83, v41, v13
  v_dot2c_f32_bf16 v84, v42, v12
  v_dot2c_f32_bf16 v85, v42, v13
  v_dot2c_f32_bf16 v86, v43, v12
  v_dot2c_f32_bf16 v87, v43, v13
  s_add_u32 m0, s72, 3072
  s_add_u32 s81, s74, 43008
  buffer_load_dwordx4 v253, s[24:27], s81 offen lds
  s_waitcnt vmcnt(13)
  v_dot2c_f32_bf16 v80, v44, v12
  v_dot2c_f32_bf16 v81, v44, v13
  v_dot2c_f32_bf16 v82, v45, v12
  v_dot2c_f32_bf16 v83, v45, v13
  v_dot2c_f32_bf16 v84, v46, v12
  v_dot2c_f32_bf16 v85, v46, v13
  v_dot2c_f32_bf16 v86, v47, v12
  v_dot2c_f32_bf16 v87, v47, v13
  s_add_u32 s74, s71, 229376
  s_add_u32 m0, s72, 16384
  s_add_u32 s81, s74, 0
  buffer_load_dwordx4 v253, s[24:27], s81 offen lds
  s_waitcnt vmcnt(13)
  v_dot2c_f32_bf16 v80, v48, v12
  v_dot2c_f32_bf16 v81, v48, v13
  v_dot2c_f32_bf16 v82, v49, v12
  v_dot2c_f32_bf16 v83, v49, v13
  v_dot2c_f32_bf16 v84, v50, v12
  v_dot2c_f32_bf16 v85, v50, v13
  v_dot2c_f32_bf16 v86, v51, v12
  v_dot2c_f32_bf16 v87, v51, v13
  s_add_u32 m0, s72, 17408
  s_add_u32 s81, s74, 14336
  buffer_load_dwordx4 v253, s[24:27], s81 offen lds
  s_waitcnt vmcnt(13)
  v_dot2c_f32_bf16 v80, v52, v12
  v_dot2c_f32_bf16 v81, v52, v13
  v_dot2c_f32_bf16 v82, v53, v12
  v_dot2c_f32_bf16 v83, v53, v13
  v_dot2c_f32_bf16 v84, v54, v12
  v_dot2c_f32_bf16 v85, v54, v13
  v_dot2c_f32_bf16 v86, v55, v12
  v_dot2c_f32_bf16 v87, v55, v13
  s_add_u32 m0, s72, 18432
  s_add_u32 s81, s74, 28672
  buffer_load_dwordx4 v253, s[24:27], s81 offen lds
  s_waitcnt vmcnt(13)
  v_dot2c_f32_bf16 v80, v56, v12
  v_dot2c_f32_bf16 v81, v56, v13
  v_dot2c_f32_bf16 v82, v57, v12
  v_dot2c_f32_bf16 v83, v57, v13
  v_dot2c_f32_bf16 v84, v58, v12
  v_dot2c_f32_bf16 v85, v58, v13
  v_dot2c_f32_bf16 v86, v59, v12
  v_dot2c_f32_bf16 v87, v59, v13
  s_add_u32 m0, s72, 19456
  s_add_u32 s81, s74, 43008
  buffer_load_dwordx4 v253, s[24:27], s81 offen lds
  s_waitcnt vmcnt(13)
  v_dot2c_f32_bf16 v80, v60, v12
  v_dot2c_f32_bf16 v81, v60, v13
  v_dot2c_f32_bf16 v82, v61, v12
  v_dot2c_f32_bf16 v83, v61, v13
  v_dot2c_f32_bf16 v84, v62, v12
  v_dot2c_f32_bf16 v85, v62, v13
  v_dot2c_f32_bf16 v86, v63, v12
  v_dot2c_f32_bf16 v87, v63, v13
  s_add_u32 s74, s71, 458752
  s_add_u32 m0, s72, 32768
  s_add_u32 s81, s74, 0
  buffer_load_dwordx4 v253, s[24:27], s81 offen lds
  s_waitcnt vmcnt(13)
  v_dot2c_f32_bf16 v80, v64, v12
  v_dot2c_f32_bf16 v81, v64, v13
  v_dot2c_f32_bf16 v82, v65, v12
  v_dot2c_f32_bf16 v83, v65, v13
  v_dot2c_f32_bf16 v84, v66, v12
  v_dot2c_f32_bf16 v85, v66, v13
  v_dot2c_f32_bf16 v86, v67, v12
  v_dot2c_f32_bf16 v87, v67, v13
  s_add_u32 m0, s72, 33792
  s_add_u32 s81, s74, 14336
  buffer_load_dwordx4 v253, s[24:27], s81 offen lds
  s_waitcnt vmcnt(13)
  v_dot2c_f32_bf16 v80, v68, v12
  v_dot2c_f32_bf16 v81, v68, v13
  v_dot2c_f32_bf16 v82, v69, v12
  v_dot2c_f32_bf16 v83, v69, v13
  v_dot2c_f32_bf16 v84, v70, v12
  v_dot2c_f32_bf16 v85, v70, v13
  v_dot2c_f32_bf16 v86, v71, v12
  v_dot2c_f32_bf16 v87, v71, v13
  s_add_u32 m0, s72, 34816
  s_add_u32 s81, s74, 28672
  buffer_load_dwordx4 v253, s[24:27], s81 offen lds
  s_waitcnt vmcnt(13)
  v_dot2c_f32_bf16 v80, v72, v12
  v_dot2c_f32_bf16 v81, v72, v13
  v_dot2c_f32_bf16 v82, v73, v12
  v_dot2c_f32_bf16 v83, v73, v13
  v_dot2c_f32_bf16 v84, v74, v12
  v_dot2c_f32_bf16 v85, v74, v13
  v_dot2c_f32_bf16 v86, v75, v12
  v_dot2c_f32_bf16 v87, v75, v13
  s_add_u32 m0, s72, 35840
  s_add_u32 s81, s74, 43008
  buffer_load_dwordx4 v253, s[24:27], s81 offen lds
  s_waitcnt vmcnt(13)
  v_dot2c_f32_bf16 v80, v76, v12
  v_dot2c_f32_bf16 v81, v76, v13
  v_dot2c_f32_bf16 v82, v77, v12
  v_dot2c_f32_bf16 v83, v77, v13
  v_dot2c_f32_bf16 v84, v78, v12
  v_dot2c_f32_bf16 v85, v78, v13
  v_dot2c_f32_bf16 v86, v79, v12
  v_dot2c_f32_bf16 v87, v79, v13
  v_cvt_pk_bf16_f32 v88, v80, v81
  v_cvt_pk_bf16_f32 v89, v82, v83
  v_cvt_pk_bf16_f32 v90, v84, v85
  v_cvt_pk_bf16_f32 v91, v86, v87
  s_and_b32 s82, s78, 1
  s_lshl_b32 s82, s82, 1
  s_lshr_b32 s83, s78, 1
  s_add_u32 s82, s82, s83
  s_lshl_b32 s82, s82, 10
  v_add_u32 v8, 131072, v2
  v_add_u32 v7, s82, v8
  ds_write_b128 v7, v[88:91]
  s_waitcnt lgkmcnt(0)
  s_barrier
  ds_read_b128 v[16:19], v8 offset:0
  ds_read_b128 v[20:23], v8 offset:1024
  ds_read_b128 v[24:27], v8 offset:2048
  ds_read_b128 v[28:31], v8 offset:3072
  s_waitcnt lgkmcnt(0)
  v_mfma_f32_32x32x16_bf16 v[48:63], v[16:19], v[160:163], 0
  v_mfma_f32_32x32x16_bf16 v[48:63], v[20:23], v[164:167], v[48:63]
  v_mfma_f32_32x32x16_bf16 v[48:63], v[24:27], v[228:231], v[48:63]
  v_mfma_f32_32x32x16_bf16 v[48:63], v[28:31], v[232:235], v[48:63]
  s_nop 11
  v_mov_b32 v7, v60
  v_mov_b32 v8, v60
  s_nop 1
  v_permlane32_swap_b32 v7, v8
  v_add_f32 v8, 0x358637bd, v8
  v_rcp_f32 v8, v8
  s_nop 0
  v_pk_mul_f32 v[48:49], v[48:49], v[8:9] op_sel_hi:[1,0]
  v_pk_mul_f32 v[50:51], v[50:51], v[8:9] op_sel_hi:[1,0]
  v_pk_mul_f32 v[52:53], v[52:53], v[8:9] op_sel_hi:[1,0]
  v_pk_mul_f32 v[54:55], v[54:55], v[8:9] op_sel_hi:[1,0]
  v_pk_mul_f32 v[56:57], v[56:57], v[8:9] op_sel_hi:[1,0]
  v_pk_mul_f32 v[58:59], v[58:59], v[8:9] op_sel_hi:[1,0]
  v_pk_mul_f32 v[60:61], v[60:61], v[8:9] op_sel_hi:[1,0]
  v_pk_mul_f32 v[62:63], v[62:63], v[8:9] op_sel_hi:[1,0]
  v_cvt_pk_bf16_f32 v48, v48, v49
  v_cvt_pk_bf16_f32 v49, v50, v51
  v_cvt_pk_bf16_f32 v50, v52, v53
  v_cvt_pk_bf16_f32 v51, v54, v55
  v_cvt_pk_bf16_f32 v52, v56, v57
  v_cvt_pk_bf16_f32 v53, v58, v59
  v_cvt_pk_bf16_f32 v54, v60, v61
  v_cvt_pk_bf16_f32 v55, v62, v63
  v_and_b32 v54, v4, v54
  v_and_b32 v55, v4, v55
  s_lshl_b32 s82, s76, 2
  s_add_u32 s82, s82, s78
  s_lshl_b32 s82, s82, 4
  s_add_u32 s82, s82, s77
  s_lshl_b32 s82, s82, 11
  s_add_u32 s82, s82, 3145728
  buffer_store_dwordx4 v[48:51], v2, s[36:39], s82 offen offset:0 sc1
  buffer_store_dwordx4 v[52:55], v2, s[36:39], s82 offen offset:1024 sc1
  s_lshl_b32 s92, s76, 4
  s_add_u32 s92, s92, s77
  s_lshl_b32 s92, s92, 2
  s_add_u32 s92, s92, s78
  s_lshl_b32 s92, s92, 3
  s_add_u32 s92, s92, 262144
  s_waitcnt vmcnt(0)
  v_mov_b32 v14, s97
  v_mov_b32 v15, s96
  v_mov_b32 v13, 0
  s_mov_b64 s[100:101], exec
  s_mov_b64 exec, 1
  s_cmp_eq_u32 s79, 0
  s_cbranch_scc1 L_fg_11
  buffer_store_dwordx2 v[14:15], v13, s[36:39], s92 offen
  s_branch L_fe_12
L_fg_11:
  buffer_store_dwordx2 v[14:15], v13, s[36:39], s92 offen sc1
L_fe_12:
  s_mov_b64 exec, s[100:101]
  s_cmp_ge_u32 s77, 14
  s_cbranch_scc1 L_IDLE
  s_lshr_b32 s82, s78, 1
  s_add_u32 s82, s82, s95
  s_mul_i32 s82, s82, 28672
  s_and_b32 s83, s78, 1
  s_lshl_b32 s84, s94, 1
  s_add_u32 s83, s83, s84
  s_lshl_b32 s83, s83, 6
  s_add_u32 s7, s82, s83
  v_and_b32 v7, 31, v1
  v_mul_u32_u24 v7, 896, v7
  v_lshl_add_u32 v248, v3, 4, v7
  buffer_load_dwordx4 v[80:83], v248, s[8:11], s7 offen
  buffer_load_dwordx4 v[84:87], v248, s[8:11], s7 offen offset:32
  s_cmp_lg_u32 s78, 0
  s_cbranch_scc1 L_w0_13
  v_and_b32 v13, 31, v1
  v_lshrrev_b32 v12, 1, v13
  v_lshlrev_b32 v12, 2, v12
  v_and_b32 v15, 1, v13
  v_add_u32 v12, v12, v15
  s_lshl_b32 s82, s93, 1
  v_add_u32 v12, s82, v12
  v_lshlrev_b32 v12, 3, v12
  s_lshl_b32 s92, s76, 9
  s_add_u32 s92, s92, 262144
  v_add_u32 v12, s92, v12
  v_min_u32 v13, 27, v13
  v_mul_u32_u24 v13, 7, v13
  v_add_u32 v13, s94, v13
  v_lshlrev_b32 v13, 8, v13
  v_add_u32 v13, 1572864, v13
  v_sub_u32 v13, v13, v12
  v_not_b32 v15, v4
  v_and_b32 v13, v13, v15
  v_add_u32 v12, v12, v13
  s_mov_b32 s92, 0
  s_mov_b32 s88, 0
L_poll_14:
  buffer_load_dwordx2 v[14:15], v12, s[36:39], s92 offen sc1
  s_waitcnt vmcnt(0)
  v_and_b32 v13, 0xfffffff8, v14
  v_xor_b32 v13, s80, v13
  v_xor_b32 v15, s96, v15
  v_or_b32 v13, v13, v15
  v_cmp_ne_u32 vcc, 0, v13
  s_add_u32 s88, s88, 1
  s_cmp_ge_u32 s88, 0x100000
  s_cbranch_scc1 L_pd_15
  s_cmp_lg_u64 vcc, 0
  s_cbranch_scc1 L_poll_14
L_pd_15:
L_w0_13:
  s_barrier
  s_lshl_b32 s89, s95, 15
  s_lshl_b32 s82, s78, 13
  s_add_u32 s89, s89, s82
  s_add_u32 s89, s89, 3145728
  s_and_b32 s82, s94, 1
  s_lshl_b32 s82, s82, 12
  s_add_u32 s90, s89, s82
  s_sub_u32 s91, s89, s82
  s_add_u32 s81, s90, 0
  buffer_load_dwordx4 v[16:19], v2, s[36:39], s81 offen offset:0 sc1
  buffer_load_dwordx4 v[24:27], v2, s[36:39], s81 offen offset:1024 sc1
  s_add_u32 s81, s90, 32768
  buffer_load_dwordx4 v[20:23], v2, s[36:39], s81 offen offset:0 sc1
  buffer_load_dwordx4 v[28:31], v2, s[36:39], s81 offen offset:1024 sc1
  s_add_u32 s81, s90, 2048
  buffer_load_dwordx4 v[32:35], v2, s[36:39], s81 offen offset:0 sc1
  buffer_load_dwordx4 v[40:43], v2, s[36:39], s81 offen offset:1024 sc1
  s_add_u32 s81, s90, 34816
  buffer_load_dwordx4 v[36:39], v2, s[36:39], s81 offen offset:0 sc1
  buffer_load_dwordx4 v[44:47], v2, s[36:39], s81 offen offset:1024 sc1
  s_waitcnt vmcnt(8)
  v_permlane32_swap_b32 v80, v82
  v_permlane32_swap_b32 v81, v83
  v_permlane32_swap_b32 v84, v86
  v_permlane32_swap_b32 v85, v87
  v_lshlrev_b32 v88, 16, v80
  v_and_b32 v89, 0xffff0000, v80
  v_lshlrev_b32 v90, 16, v81
  v_and_b32 v91, 0xffff0000, v81
  v_lshlrev_b32 v92, 16, v82
  v_and_b32 v93, 0xffff0000, v82
  v_lshlrev_b32 v94, 16, v83
  v_and_b32 v95, 0xffff0000, v83
  v_lshlrev_b32 v96, 16, v84
  v_and_b32 v97, 0xffff0000, v84
  v_lshlrev_b32 v98, 16, v85
  v_and_b32 v99, 0xffff0000, v85
  v_lshlrev_b32 v100, 16, v86
  v_and_b32 v101, 0xffff0000, v86
  v_lshlrev_b32 v102, 16, v87
  v_and_b32 v103, 0xffff0000, v87
  s_waitcnt vmcnt(4)
  s_add_u32 s81, s91, 4096
  buffer_load_dwordx4 v[48:51], v2, s[36:39], s81 offen offset:0 sc1
  buffer_load_dwordx4 v[56:59], v2, s[36:39], s81 offen offset:1024 sc1
  s_add_u32 s81, s91, 36864
  buffer_load_dwordx4 v[52:55], v2, s[36:39], s81 offen offset:0 sc1
  buffer_load_dwordx4 v[60:63], v2, s[36:39], s81 offen offset:1024 sc1
  v_mfma_f32_32x32x16_bf16 v[128:143], a[192:195], v[16:19], 0
  v_mfma_f32_32x32x16_bf16 v[144:159], a[196:199], v[16:19], 0
  v_mfma_f32_32x32x16_bf16 v[160:175], a[192:195], v[20:23], 0
  v_mfma_f32_32x32x16_bf16 v[176:191], a[196:199], v[20:23], 0
  v_mfma_f32_32x32x16_bf16 v[128:143], a[200:203], v[24:27], v[128:143]
  v_mfma_f32_32x32x16_bf16 v[144:159], a[204:207], v[24:27], v[144:159]
  v_mfma_f32_32x32x16_bf16 v[160:175], a[200:203], v[28:31], v[160:175]
  v_mfma_f32_32x32x16_bf16 v[176:191], a[204:207], v[28:31], v[176:191]
  s_waitcnt vmcnt(4)
  s_add_u32 s81, s91, 6144
  buffer_load_dwordx4 v[64:67], v2, s[36:39], s81 offen offset:0 sc1
  buffer_load_dwordx4 v[72:75], v2, s[36:39], s81 offen offset:1024 sc1
  s_add_u32 s81, s91, 38912
  buffer_load_dwordx4 v[68:71], v2, s[36:39], s81 offen offset:0 sc1
  buffer_load_dwordx4 v[76:79], v2, s[36:39], s81 offen offset:1024 sc1
  s_lshr_b32 s82, s78, 1
  s_add_u32 s82, s82, s95
  s_and_b32 s83, s78, 1
  s_lshl_b32 s84, s94, 1
  s_add_u32 s83, s83, s84
  s_mul_i32 s89, s82, 28
  s_lshl_b32 s84, s83, 1
  s_add_u32 s89, s89, s84
  s_lshl_b32 s89, s89, 10
  s_add_u32 s89, s89, 5242880
  s_mul_i32 s90, s82, 7
  s_add_u32 s90, s90, s94
  s_lshl_b32 s90, s90, 9
  s_and_b32 s83, s78, 1
  s_lshl_b32 s83, s83, 3
  s_add_u32 s90, s90, s83
  s_add_u32 s90, s90, 7340032
  v_lshlrev_b32 v104, 4, v1
  v_lshl_or_b32 v104, v3, 30, v104
  v_mfma_f32_32x32x16_bf16 v[128:143], a[208:211], v[32:35], v[128:143]
  v_mfma_f32_32x32x16_bf16 v[144:159], a[212:215], v[32:35], v[144:159]
  v_mfma_f32_32x32x16_bf16 v[160:175], a[208:211], v[36:39], v[160:175]
  v_mfma_f32_32x32x16_bf16 v[176:191], a[212:215], v[36:39], v[176:191]
  s_add_u32 s74, s71, 688128
  s_add_u32 m0, s72, 49152
  s_add_u32 s81, s74, 0
  buffer_load_dwordx4 v253, s[24:27], s81 offen lds
  s_add_u32 m0, s72, 50176
  s_add_u32 s81, s74, 14336
  buffer_load_dwordx4 v253, s[24:27], s81 offen lds
  v_mfma_f32_32x32x16_bf16 v[128:143], a[216:219], v[40:43], v[128:143]
  v_mfma_f32_32x32x16_bf16 v[144:159], a[220:223], v[40:43], v[144:159]
  v_mfma_f32_32x32x16_bf16 v[160:175], a[216:219], v[44:47], v[160:175]
  v_mfma_f32_32x32x16_bf16 v[176:191], a[220:223], v[44:47], v[176:191]
  s_add_u32 m0, s72, 51200
  s_add_u32 s81, s74, 28672
  buffer_load_dwordx4 v253, s[24:27], s81 offen lds
  s_add_u32 m0, s72, 52224
  s_add_u32 s81, s74, 43008
  buffer_load_dwordx4 v253, s[24:27], s81 offen lds
  s_waitcnt vmcnt(8)
  v_mfma_f32_32x32x16_bf16 v[128:143], a[224:227], v[48:51], v[128:143]
  v_mfma_f32_32x32x16_bf16 v[144:159], a[228:231], v[48:51], v[144:159]
  v_mfma_f32_32x32x16_bf16 v[160:175], a[224:227], v[52:55], v[160:175]
  v_mfma_f32_32x32x16_bf16 v[176:191], a[228:231], v[52:55], v[176:191]
  s_add_u32 s74, s71, 917504
  s_add_u32 m0, s72, 65536
  s_add_u32 s81, s74, 0
  buffer_load_dwordx4 v253, s[24:27], s81 offen lds
  s_add_u32 m0, s72, 66560
  s_add_u32 s81, s74, 14336
  buffer_load_dwordx4 v253, s[24:27], s81 offen lds
  s_add_u32 m0, s72, 67584
  s_add_u32 s81, s74, 28672
  buffer_load_dwordx4 v253, s[24:27], s81 offen lds
  v_mfma_f32_32x32x16_bf16 v[128:143], a[232:235], v[56:59], v[128:143]
  v_mfma_f32_32x32x16_bf16 v[144:159], a[236:239], v[56:59], v[144:159]
  v_mfma_f32_32x32x16_bf16 v[160:175], a[232:235], v[60:63], v[160:175]
  v_mfma_f32_32x32x16_bf16 v[176:191], a[236:239], v[60:63], v[176:191]
  s_add_u32 m0, s72, 68608
  s_add_u32 s81, s74, 43008
  buffer_load_dwordx4 v253, s[24:27], s81 offen lds
  s_add_u32 s74, s71, 1146880
  s_add_u32 m0, s72, 81920
  s_add_u32 s81, s74, 0
  buffer_load_dwordx4 v253, s[24:27], s81 offen lds
  s_add_u32 m0, s72, 82944
  s_add_u32 s81, s74, 14336
  buffer_load_dwordx4 v253, s[24:27], s81 offen lds
  s_waitcnt vmcnt(10)
  v_mfma_f32_32x32x16_bf16 v[128:143], a[240:243], v[64:67], v[128:143]
  v_mfma_f32_32x32x16_bf16 v[144:159], a[244:247], v[64:67], v[144:159]
  v_mfma_f32_32x32x16_bf16 v[160:175], a[240:243], v[68:71], v[160:175]
  v_mfma_f32_32x32x16_bf16 v[176:191], a[244:247], v[68:71], v[176:191]
  s_add_u32 m0, s72, 83968
  s_add_u32 s81, s74, 28672
  buffer_load_dwordx4 v253, s[24:27], s81 offen lds
  s_add_u32 m0, s72, 84992
  s_add_u32 s81, s74, 43008
  buffer_load_dwordx4 v253, s[24:27], s81 offen lds
  s_add_u32 s74, s71, 1376256
  s_add_u32 m0, s72, 98304
  s_add_u32 s81, s74, 0
  buffer_load_dwordx4 v253, s[24:27], s81 offen lds
  v_mfma_f32_32x32x16_bf16 v[128:143], a[248:251], v[72:75], v[128:143]
  v_mfma_f32_32x32x16_bf16 v[144:159], a[252:255], v[72:75], v[144:159]
  v_mfma_f32_32x32x16_bf16 v[160:175], a[248:251], v[76:79], v[160:175]
  v_mfma_f32_32x32x16_bf16 v[176:191], a[252:255], v[76:79], v[176:191]
  s_add_u32 m0, s72, 99328
  s_add_u32 s81, s74, 14336
  buffer_load_dwordx4 v253, s[24:27], s81 offen lds
  s_add_u32 m0, s72, 100352
  s_add_u32 s81, s74, 28672
  buffer_load_dwordx4 v253, s[24:27], s81 offen lds
  s_add_u32 m0, s72, 101376
  s_add_u32 s81, s74, 43008
  buffer_load_dwordx4 v253, s[24:27], s81 offen lds
  v_add_u32 v249, 114688, v2
  s_nop 11
  s_cmp_lg_u32 s78, 0
  s_cbranch_scc1 L_rw_17
  ds_write_b128 v249, v[144:147] offset:20480
  ds_write_b128 v249, v[148:151] offset:21504
  ds_write_b128 v249, v[152:155] offset:22528
  ds_write_b128 v249, v[156:159] offset:23552
  ds_write_b128 v249, v[160:163] offset:28672
  ds_write_b128 v249, v[164:167] offset:29696
  ds_write_b128 v249, v[168:171] offset:30720
  ds_write_b128 v249, v[172:175] offset:31744
  ds_write_b128 v249, v[176:179] offset:36864
  ds_write_b128 v249, v[180:183] offset:37888
  ds_write_b128 v249, v[184:187] offset:38912
  ds_write_b128 v249, v[188:191] offset:39936
  s_branch L_rw_16
L_rw_17:
  s_cmp_lg_u32 s78, 1
  s_cbranch_scc1 L_rw_18
  ds_write_b128 v249, v[128:131] offset:0
  ds_write_b128 v249, v[132:135] offset:1024
  ds_write_b128 v249, v[136:139] offset:2048
  ds_write_b128 v249, v[140:143] offset:3072
  ds_write_b128 v249, v[160:163] offset:32768
  ds_write_b128 v249, v[164:167] offset:33792
  ds_write_b128 v249, v[168:171] offset:34816
  ds_write_b128 v249, v[172:175] offset:35840
  ds_write_b128 v249, v[176:179] offset:40960
  ds_write_b128 v249, v[180:183] offset:41984
  ds_write_b128 v249, v[184:187] offset:43008
  ds_write_b128 v249, v[188:191] offset:44032
  v_pk_mov_b32 v[128:129], v[144:145], v[144:145] op_sel:[0,1]
  v_pk_mov_b32 v[130:131], v[146:147], v[146:147] op_sel:[0,1]
  v_pk_mov_b32 v[132:133], v[148:149], v[148:149] op_sel:[0,1]
  v_pk_mov_b32 v[134:135], v[150:151], v[150:151] op_sel:[0,1]
  v_pk_mov_b32 v[136:137], v[152:153], v[152:153] op_sel:[0,1]
  v_pk_mov_b32 v[138:139], v[154:155], v[154:155] op_sel:[0,1]
  v_pk_mov_b32 v[140:141], v[156:157], v[156:157] op_sel:[0,1]
  v_pk_mov_b32 v[142:143], v[158:159], v[158:159] op_sel:[0,1]
  s_branch L_rw_16
L_rw_18:
  s_cmp_lg_u32 s78, 2
  s_cbranch_scc1 L_rw_19
  ds_write_b128 v249, v[128:131] offset:4096
  ds_write_b128 v249, v[132:135] offset:5120
  ds_write_b128 v249, v[136:139] offset:6144
  ds_write_b128 v249, v[140:143] offset:7168
  ds_write_b128 v249, v[144:147] offset:12288
  ds_write_b128 v249, v[148:151] offset:13312
  ds_write_b128 v249, v[152:155] offset:14336
  ds_write_b128 v249, v[156:159] offset:15360
  ds_write_b128 v249, v[176:179] offset:45056
  ds_write_b128 v249, v[180:183] offset:46080
  ds_write_b128 v249, v[184:187] offset:47104
  ds_write_b128 v249, v[188:191] offset:48128
  v_pk_mov_b32 v[128:129], v[160:161], v[160:161] op_sel:[0,1]
  v_pk_mov_b32 v[130:131], v[162:163], v[162:163] op_sel:[0,1]
  v_pk_mov_b32 v[132:133], v[164:165], v[164:165] op_sel:[0,1]
  v_pk_mov_b32 v[134:135], v[166:167], v[166:167] op_sel:[0,1]
  v_pk_mov_b32 v[136:137], v[168:169], v[168:169] op_sel:[0,1]
  v_pk_mov_b32 v[138:139], v[170:171], v[170:171] op_sel:[0,1]
  v_pk_mov_b32 v[140:141], v[172:173], v[172:173] op_sel:[0,1]
  v_pk_mov_b32 v[142:143], v[174:175], v[174:175] op_sel:[0,1]
  s_branch L_rw_16
L_rw_19:
  ds_write_b128 v249, v[128:131] offset:8192
  ds_write_b128 v249, v[132:135] offset:9216
  ds_write_b128 v249, v[136:139] offset:10240
  ds_write_b128 v249, v[140:143] offset:11264
  ds_write_b128 v249, v[144:147] offset:16384
  ds_write_b128 v249, v[148:151] offset:17408
  ds_write_b128 v249, v[152:155] offset:18432
  ds_write_b128 v249, v[156:159] offset:19456
  ds_write_b128 v249, v[160:163] offset:24576
  ds_write_b128 v249, v[164:167] offset:25600
  ds_write_b128 v249, v[168:171] offset:26624
  ds_write_b128 v249, v[172:175] offset:27648
  v_pk_mov_b32 v[128:129], v[176:177], v[176:177] op_sel:[0,1]
  v_pk_mov_b32 v[130:131], v[178:179], v[178:179] op_sel:[0,1]
  v_pk_mov_b32 v[132:133], v[180:181], v[180:181] op_sel:[0,1]
  v_pk_mov_b32 v[134:135], v[182:183], v[182:183] op_sel:[0,1]
  v_pk_mov_b32 v[136:137], v[184:185], v[184:185] op_sel:[0,1]
  v_pk_mov_b32 v[138:139], v[186:187], v[186:187] op_sel:[0,1]
  v_pk_mov_b32 v[140:141], v[188:189], v[188:189] op_sel:[0,1]
  v_pk_mov_b32 v[142:143], v[190:191], v[190:191] op_sel:[0,1]
L_rw_16:
  s_waitcnt lgkmcnt(0)
  s_barrier
  s_mul_i32 s82, s78, 12288
  v_add_u32 v7, s82, v249
  ds_read_b128 v[144:147], v7 offset:0
  ds_read_b128 v[148:151], v7 offset:1024
  ds_read_b128 v[152:155], v7 offset:2048
  ds_read_b128 v[156:159], v7 offset:3072
  ds_read_b128 v[160:163], v7 offset:4096
  ds_read_b128 v[164:167], v7 offset:5120
  ds_read_b128 v[168:171], v7 offset:6144
  ds_read_b128 v[172:175], v7 offset:7168
  ds_read_b128 v[176:179], v7 offset:8192
  ds_read_b128 v[180:183], v7 offset:9216
  ds_read_b128 v[184:187], v7 offset:10240
  ds_read_b128 v[188:191], v7 offset:11264
  s_waitcnt lgkmcnt(8)
  v_pk_add_f32 v[128:129], v[128:129], v[144:145]
  v_pk_add_f32 v[130:131], v[130:131], v[146:147]
  v_pk_add_f32 v[132:133], v[132:133], v[148:149]
  v_pk_add_f32 v[134:135], v[134:135], v[150:151]
  v_pk_add_f32 v[136:137], v[136:137], v[152:153]
  v_pk_add_f32 v[138:139], v[138:139], v[154:155]
  v_pk_add_f32 v[140:141], v[140:141], v[156:157]
  v_pk_add_f32 v[142:143], v[142:143], v[158:159]
  s_waitcnt lgkmcnt(4)
  v_pk_add_f32 v[128:129], v[128:129], v[160:161]
  v_pk_add_f32 v[130:131], v[130:131], v[162:163]
  v_pk_add_f32 v[132:133], v[132:133], v[164:165]
  v_pk_add_f32 v[134:135], v[134:135], v[166:167]
  v_pk_add_f32 v[136:137], v[136:137], v[168:169]
  v_pk_add_f32 v[138:139], v[138:139], v[170:171]
  v_pk_add_f32 v[140:141], v[140:141], v[172:173]
  v_pk_add_f32 v[142:143], v[142:143], v[174:175]
  s_waitcnt lgkmcnt(0)
  v_pk_add_f32 v[128:129], v[128:129], v[176:177]
  v_pk_add_f32 v[130:131], v[130:131], v[178:179]
  v_pk_add_f32 v[132:133], v[132:133], v[180:181]
  v_pk_add_f32 v[134:135], v[134:135], v[182:183]
  v_pk_add_f32 v[136:137], v[136:137], v[184:185]
  v_pk_add_f32 v[138:139], v[138:139], v[186:187]
  v_pk_add_f32 v[140:141], v[140:141], v[188:189]
  v_pk_add_f32 v[142:143], v[142:143], v[190:191]
  v_pk_add_f32 v[128:129], v[128:129], v[88:89]
  v_pk_add_f32 v[130:131], v[130:131], v[90:91]
  v_pk_add_f32 v[132:133], v[132:133], v[92:93]
  v_pk_add_f32 v[134:135], v[134:135], v[94:95]
  v_pk_add_f32 v[136:137], v[136:137], v[96:97]
  v_pk_add_f32 v[138:139], v[138:139], v[98:99]
  v_pk_add_f32 v[140:141], v[140:141], v[100:101]
  v_pk_add_f32 v[142:143], v[142:143], v[102:103]
  v_cvt_pk_bf16_f32 v240, v128, v129
  v_cvt_pk_bf16_f32 v241, v130, v131
  v_cvt_pk_bf16_f32 v242, v132, v133
  v_cvt_pk_bf16_f32 v243, v134, v135
  v_cvt_pk_bf16_f32 v244, v136, v137
  v_cvt_pk_bf16_f32 v245, v138, v139
  v_cvt_pk_bf16_f32 v246, v140, v141
  v_cvt_pk_bf16_f32 v247, v142, v143
  buffer_store_dwordx4 v[240:243], v2, s[36:39], s89 offen sc1
  buffer_store_dwordx4 v[244:247], v2, s[36:39], s89 offen offset:1024 sc1
  v_pk_add_f32 v[8:9], v[128:129], v[130:131]
  v_pk_mul_f32 v[10:11], v[128:129], v[128:129]
  v_pk_fma_f32 v[10:11], v[130:131], v[130:131], v[10:11]
  v_pk_add_f32 v[8:9], v[8:9], v[132:133]
  v_pk_fma_f32 v[10:11], v[132:133], v[132:133], v[10:11]
  v_pk_add_f32 v[8:9], v[8:9], v[134:135]
  v_pk_fma_f32 v[10:11], v[134:135], v[134:135], v[10:11]
  v_pk_add_f32 v[8:9], v[8:9], v[136:137]
  v_pk_fma_f32 v[10:11], v[136:137], v[136:137], v[10:11]
  v_pk_add_f32 v[8:9], v[8:9], v[138:139]
  v_pk_fma_f32 v[10:11], v[138:139], v[138:139], v[10:11]
  v_pk_add_f32 v[8:9], v[8:9], v[140:141]
  v_pk_fma_f32 v[10:11], v[140:141], v[140:141], v[10:11]
  v_pk_add_f32 v[8:9], v[8:9], v[142:143]
  v_pk_fma_f32 v[10:11], v[142:143], v[142:143], v[10:11]
  v_add_f32 v8, v8, v9
  v_add_f32 v9, v10, v11
  v_mov_b32 v10, v8
  s_nop 1
  v_permlane32_swap_b32 v8, v10
  v_add_f32 v8, v8, v10
  v_mov_b32 v10, v9
  s_nop 1
  v_permlane32_swap_b32 v9, v10
  v_add_f32 v9, v9, v10
  buffer_store_dwordx2 v[8:9], v104, s[36:39], s90 offen sc1
  s_lshl_b32 s92, s76, 4
  s_add_u32 s92, s92, s77
  s_lshl_b32 s92, s92, 2
  s_add_u32 s92, s92, s78
  s_lshl_b32 s92, s92, 3
  s_add_u32 s92, s92, 524288
  s_waitcnt vmcnt(0)
  v_mov_b32 v14, s97
  v_mov_b32 v15, s96
  v_mov_b32 v13, 0
  s_mov_b64 s[100:101], exec
  s_mov_b64 exec, 1
  s_cmp_eq_u32 s79, 0
  s_cbranch_scc1 L_fg_21
  buffer_store_dwordx2 v[14:15], v13, s[36:39], s92 offen
  s_branch L_fe_22
L_fg_21:
  buffer_store_dwordx2 v[14:15], v13, s[36:39], s92 offen sc1
L_fe_22:
  s_mov_b64 exec, s[100:101]
  v_bfe_u32 v7, v1, 2, 2
  v_lshl_add_u32 v11, v3, 2, v7
  v_lshlrev_b32 v11, 8, v11
  v_bfe_u32 v12, v1, 4, 1
  v_lshl_add_u32 v11, v12, 5, v11
  v_and_b32 v12, 3, v1
  v_lshl_add_u32 v11, v12, 3, v11
  v_xor_b32 v12, 0, v7
  v_lshl_add_u32 v226, v12, 6, v11
  v_add_u32 v230, 0x10000, v226
  v_xor_b32 v12, 1, v7
  v_lshl_add_u32 v227, v12, 6, v11
  v_add_u32 v231, 0x10000, v227
  v_xor_b32 v12, 2, v7
  v_lshl_add_u32 v228, v12, 6, v11
  v_add_u32 v232, 0x10000, v228
  v_xor_b32 v12, 3, v7
  v_lshl_add_u32 v229, v12, 6, v11
  v_add_u32 v233, 0x10000, v229
  s_and_b32 s87, s76, 1
  s_lshl_b32 s87, s87, 1
  s_add_u32 s87, s87, s93
  s_mov_b32 s87, 0
  s_mul_i32 s73, s78, 392
  s_lshl_b32 s82, s94, 1
  s_add_u32 s73, s73, s82
  s_lshl_b32 s73, s73, 10
  s_add_u32 s73, s73, 16777216
  s_add_u32 s82, s87, 0
  s_and_b32 s82, s82, 3
  s_mul_i32 s82, s82, 100352
  s_add_u32 s3, s73, s82
  s_add_u32 s82, s3, 0
  buffer_load_dwordx4 a[0:3], v2, s[36:39], s82 offen offset:0 sc1
  buffer_load_dwordx4 a[4:7], v2, s[36:39], s82 offen offset:1024 sc1
  s_add_u32 s82, s3, 14336
  buffer_load_dwordx4 a[8:11], v2, s[36:39], s82 offen offset:0 sc1
  buffer_load_dwordx4 a[12:15], v2, s[36:39], s82 offen offset:1024 sc1
  s_add_u32 s82, s3, 28672
  buffer_load_dwordx4 a[16:19], v2, s[36:39], s82 offen offset:0 sc1
  buffer_load_dwordx4 a[20:23], v2, s[36:39], s82 offen offset:1024 sc1
  s_add_u32 s82, s3, 43008
  buffer_load_dwordx4 a[24:27], v2, s[36:39], s82 offen offset:0 sc1
  buffer_load_dwordx4 a[28:31], v2, s[36:39], s82 offen offset:1024 sc1
  s_cmp_lg_u32 s78, 0
  s_cbranch_scc1 L_w0_23
  v_lshlrev_b32 v12, 3, v1
  s_lshl_b32 s92, s76, 9
  s_add_u32 s92, s92, 524288
  v_add_u32 v12, s92, v12
  v_and_b32 v13, 3, v1
  s_lshl_b32 s82, s77, 2
  v_add_u32 v13, s82, v13
  v_lshlrev_b32 v13, 8, v13
  v_add_u32 v13, 1703936, v13
  v_sub_u32 v13, v13, v12
  v_lshrrev_b32 v15, 3, v1
  v_add_u32 v15, 1, v15
  v_lshrrev_b32 v15, 3, v15
  v_sub_u32 v15, 0, v15
  v_and_b32 v13, v13, v15
  v_add_u32 v12, v12, v13
  s_mov_b32 s92, 0
  s_mov_b32 s88, 0
L_poll_24:
  buffer_load_dwordx2 v[14:15], v12, s[36:39], s92 offen sc1
  s_waitcnt vmcnt(0)
  v_and_b32 v13, 0xfffffff8, v14
  v_xor_b32 v13, s80, v13
  v_xor_b32 v15, s96, v15
  v_or_b32 v13, v13, v15
  v_cmp_ne_u32 vcc, 0, v13
  s_add_u32 s88, s88, 1
  s_cmp_ge_u32 s88, 0x100000
  s_cbranch_scc1 L_pd_25
  s_cmp_lg_u64 vcc, 0
  s_cbranch_scc1 L_poll_24
L_pd_25:
L_w0_23:
  s_barrier
  s_lshl_b32 s82, s76, 2
  s_add_u32 s82, s82, s78
  s_mul_i32 s89, s82, 3584
  s_add_u32 s89, s89, 7340032
  v_and_b32 v7, 31, v1
  v_lshlrev_b32 v7, 4, v7
  v_lshl_add_u32 v7, v3, 11, v7
  v_lshl_or_b32 v12, v3, 30, v7
  s_mul_i32 s91, s82, 28672
  s_add_u32 s91, s91, 5242880
  s_add_u32 s5, s91, 0
  buffer_load_dwordx4 v[16:19], v2, s[36:39], s5 offen offset:0 sc1
  buffer_load_dwordx4 v[20:23], v2, s[36:39], s5 offen offset:1024 sc1
  buffer_load_dwordx4 v[24:27], v2, s[36:39], s5 offen offset:2048 sc1
  buffer_load_dwordx4 v[28:31], v2, s[36:39], s5 offen offset:3072 sc1
  buffer_load_dwordx4 v[96:99], v7, s[36:39], s89 offen offset:0 sc1
  buffer_load_dwordx4 v[100:103], v7, s[36:39], s89 offen offset:512 sc1
  buffer_load_dwordx4 v[104:107], v7, s[36:39], s89 offen offset:1024 sc1
  buffer_load_dwordx4 v[108:111], v12, s[36:39], s89 offen offset:1536 sc1
  s_add_u32 s5, s91, 4096
  buffer_load_dwordx4 v[32:35], v2, s[36:39], s5 offen offset:0 sc1
  buffer_load_dwordx4 v[36:39], v2, s[36:39], s5 offen offset:1024 sc1
  buffer_load_dwordx4 v[40:43], v2, s[36:39], s5 offen offset:2048 sc1
  buffer_load_dwordx4 v[44:47], v2, s[36:39], s5 offen offset:3072 sc1
  s_add_u32 s5, s91, 8192
  buffer_load_dwordx4 v[48:51], v2, s[36:39], s5 offen offset:0 sc1
  s_lshl_b32 s82, s77, 12
  s_add_u32 s82, s82, 1769472
  buffer_load_dwordx4 v[112:115], v2, s[36:39], s82 offen offset:0 sc1
  buffer_load_dwordx4 v[116:119], v2, s[36:39], s82 offen offset:1024 sc1
  buffer_load_dwordx4 v[120:123], v2, s[36:39], s82 offen offset:2048 sc1
  buffer_load_dwordx4 v[124:127], v2, s[36:39], s82 offen offset:3072 sc1
  ds_read_b64_tr_b16 v[192:193], v226 offset:0
  ds_read_b64_tr_b16 v[194:195], v226 offset:2048
  ds_read_b64_tr_b16 v[196:197], v227 offset:0
  ds_read_b64_tr_b16 v[198:199], v227 offset:2048
  ds_read_b64_tr_b16 v[200:201], v228 offset:0
  ds_read_b64_tr_b16 v[202:203], v228 offset:2048
  ds_read_b64_tr_b16 v[204:205], v229 offset:0
  ds_read_b64_tr_b16 v[206:207], v229 offset:2048
  s_waitcnt lgkmcnt(0)
  s_waitcnt vmcnt(16)
  v_mfma_f32_32x32x16_bf16 v[128:143], v[192:195], v[16:19], 0
  ds_read_b64_tr_b16 v[208:209], v226 offset:4096
  ds_read_b64_tr_b16 v[210:211], v226 offset:6144
  ds_read_b64_tr_b16 v[212:213], v227 offset:4096
  ds_read_b64_tr_b16 v[214:215], v227 offset:6144
  ds_read_b64_tr_b16 v[216:217], v228 offset:4096
  ds_read_b64_tr_b16 v[218:219], v228 offset:6144
  ds_read_b64_tr_b16 v[220:221], v229 offset:4096
  ds_read_b64_tr_b16 v[222:223], v229 offset:6144
  v_mfma_f32_32x32x16_bf16 v[144:159], v[196:199], v[16:19], 0
  buffer_load_dwordx4 v[52:55], v2, s[36:39], s5 offen offset:1024 sc1
  v_mfma_f32_32x32x16_bf16 v[160:175], v[200:203], v[16:19], 0
  v_mfma_f32_32x32x16_bf16 v[176:191], v[204:207], v[16:19], 0
  s_waitcnt lgkmcnt(0)
  s_waitcnt vmcnt(16)
  v_mfma_f32_32x32x16_bf16 v[128:143], v[208:211], v[20:23], v[128:143]
  ds_read_b64_tr_b16 v[192:193], v226 offset:8192
  ds_read_b64_tr_b16 v[194:195], v226 offset:10240
  ds_read_b64_tr_b16 v[196:197], v227 offset:8192
  ds_read_b64_tr_b16 v[198:199], v227 offset:10240
  ds_read_b64_tr_b16 v[200:201], v228 offset:8192
  ds_read_b64_tr_b16 v[202:203], v228 offset:10240
  ds_read_b64_tr_b16 v[204:205], v229 offset:8192
  ds_read_b64_tr_b16 v[206:207], v229 offset:10240
  v_mfma_f32_32x32x16_bf16 v[144:159], v[212:215], v[20:23], v[144:159]
  buffer_load_dwordx4 v[56:59], v2, s[36:39], s5 offen offset:2048 sc1
  v_mfma_f32_32x32x16_bf16 v[160:175], v[216:219], v[20:23], v[160:175]
  v_mfma_f32_32x32x16_bf16 v[176:191], v[220:223], v[20:23], v[176:191]
  s_waitcnt lgkmcnt(0)
  s_waitcnt vmcnt(16)
  v_mfma_f32_32x32x16_bf16 v[128:143], v[192:195], v[24:27], v[128:143]
  ds_read_b64_tr_b16 v[208:209], v226 offset:12288
  ds_read_b64_tr_b16 v[210:211], v226 offset:14336
  ds_read_b64_tr_b16 v[212:213], v227 offset:12288
  ds_read_b64_tr_b16 v[214:215], v227 offset:14336
  ds_read_b64_tr_b16 v[216:217], v228 offset:12288
  ds_read_b64_tr_b16 v[218:219], v228 offset:14336
  ds_read_b64_tr_b16 v[220:221], v229 offset:12288
  ds_read_b64_tr_b16 v[222:223], v229 offset:14336
  v_mfma_f32_32x32x16_bf16 v[144:159], v[196:199], v[24:27], v[144:159]
  buffer_load_dwordx4 v[60:63], v2, s[36:39], s5 offen offset:3072 sc1
  v_mfma_f32_32x32x16_bf16 v[160:175], v[200:203], v[24:27], v[160:175]
  s_add_u32 s82, s3, 57344
  buffer_load_dwordx4 a[32:35], v2, s[36:39], s82 offen offset:0 sc1
  buffer_load_dwordx4 a[36:39], v2, s[36:39], s82 offen offset:1024 sc1
  v_mfma_f32_32x32x16_bf16 v[176:191], v[204:207], v[24:27], v[176:191]
  s_waitcnt lgkmcnt(0)
  s_waitcnt vmcnt(18)
  v_mfma_f32_32x32x16_bf16 v[128:143], v[208:211], v[28:31], v[128:143]
  ds_read_b64_tr_b16 v[192:193], v226 offset:16384
  ds_read_b64_tr_b16 v[194:195], v226 offset:18432
  ds_read_b64_tr_b16 v[196:197], v227 offset:16384
  ds_read_b64_tr_b16 v[198:199], v227 offset:18432
  ds_read_b64_tr_b16 v[200:201], v228 offset:16384
  ds_read_b64_tr_b16 v[202:203], v228 offset:18432
  ds_read_b64_tr_b16 v[204:205], v229 offset:16384
  ds_read_b64_tr_b16 v[206:207], v229 offset:18432
  v_mfma_f32_32x32x16_bf16 v[144:159], v[212:215], v[28:31], v[144:159]
  s_add_u32 s5, s91, 12288
  buffer_load_dwordx4 v[64:67], v2, s[36:39], s5 offen offset:0 sc1
  v_mfma_f32_32x32x16_bf16 v[160:175], v[216:219], v[28:31], v[160:175]
  v_mfma_f32_32x32x16_bf16 v[176:191], v[220:223], v[28:31], v[176:191]
  s_waitcnt vmcnt(15)
  v_add_f32 v96, v96, v98
  v_add_f32 v96, v96, v100
  v_add_f32 v96, v96, v102
  v_add_f32 v96, v96, v104
  v_add_f32 v96, v96, v106
  v_add_f32 v96, v96, v108
  v_add_f32 v96, v96, v110
  v_add_f32 v97, v97, v99
  v_add_f32 v97, v97, v101
  v_add_f32 v97, v97, v103
  v_add_f32 v97, v97, v105
  v_add_f32 v97, v97, v107
  v_add_f32 v97, v97, v109
  v_add_f32 v97, v97, v111
  v_mov_b32 v98, v96
  s_nop 1
  v_permlane32_swap_b32 v96, v98
  v_add_f32 v96, v96, v98
  v_mov_b32 v98, v97
  s_nop 1
  v_permlane32_swap_b32 v97, v98
  v_add_f32 v97, v97, v98
  v_mul_f32 v224, 2.2321428571e-03, v96
  v_mul_f32 v98, 2.2321428571e-03, v97
  v_fma_f32 v98, -v224, v224, v98
  v_max_f32 v98, 0, v98
  v_add_f32 v98, 0x3727c5ac, v98
  v_rsq_f32 v225, v98
  v_sub_f32 v99, 0, v224
  v_mul_f32 v254, v98, v225
  v_cvt_pk_bf16_f32 v100, v99, v254
  v_lshlrev_b32 v101, 16, v100
  v_and_b32 v102, 0xffff0000, v100
  v_sub_f32 v101, v99, v101
  v_sub_f32 v103, v254, v102
  v_cvt_pk_bf16_f32 v101, v101, v103
  v_and_b32 v104, 0xffff, v100
  v_lshl_or_b32 v234, v100, 16, v104
  v_and_b32 v104, 0xffff, v101
  v_or_b32 v235, v104, v102
  v_lshrrev_b32 v236, 16, v101
  v_mov_b32 v237, 0
  v_and_b32 v234, v4, v234
  v_and_b32 v235, v4, v235
  v_and_b32 v236, v4, v236
  v_mul_f32 v250, 0xc0135761, v225
  v_mul_f32 v252, v225, v225
  v_mul_f32 v252, v252, v225
  v_mul_f32 v252, 0xbdd2d3e8, v252
  v_mov_b32 v251, v250
  v_mov_b32 v253, v252
  v_mov_b32 v255, v254
  s_lshl_b32 s82, s76, 2
  s_add_u32 s82, s82, s78
  s_mul_i32 s82, s82, 112
  s_lshl_b32 s83, s77, 3
  s_add_u32 s82, s82, s83
  s_lshl_b32 s90, s82, 10
  s_add_u32 s90, s90, 8388608
  s_waitcnt lgkmcnt(0)
  s_waitcnt vmcnt(14)
  v_mfma_f32_32x32x16_bf16 v[128:143], v[192:195], v[32:35], v[128:143]
  ds_read_b64_tr_b16 v[208:209], v226 offset:20480
  ds_read_b64_tr_b16 v[210:211], v226 offset:22528
  ds_read_b64_tr_b16 v[212:213], v227 offset:20480
  ds_read_b64_tr_b16 v[214:215], v227 offset:22528
  ds_read_b64_tr_b16 v[216:217], v228 offset:20480
  ds_read_b64_tr_b16 v[218:219], v228 offset:22528
  ds_read_b64_tr_b16 v[220:221], v229 offset:20480
  ds_read_b64_tr_b16 v[222:223], v229 offset:22528
  v_mfma_f32_32x32x16_bf16 v[144:159], v[196:199], v[32:35], v[144:159]
  buffer_load_dwordx4 v[68:71], v2, s[36:39], s5 offen offset:1024 sc1
  v_mfma_f32_32x32x16_bf16 v[160:175], v[200:203], v[32:35], v[160:175]
  s_add_u32 s82, s3, 71680
  buffer_load_dwordx4 a[40:43], v2, s[36:39], s82 offen offset:0 sc1
  buffer_load_dwordx4 a[44:47], v2, s[36:39], s82 offen offset:1024 sc1
  v_mfma_f32_32x32x16_bf16 v[176:191], v[204:207], v[32:35], v[176:191]
  s_waitcnt lgkmcnt(0)
  s_waitcnt vmcnt(16)
  v_mfma_f32_32x32x16_bf16 v[128:143], v[208:211], v[36:39], v[128:143]
  ds_read_b64_tr_b16 v[192:193], v226 offset:24576
  ds_read_b64_tr_b16 v[194:195], v226 offset:26624
  ds_read_b64_tr_b16 v[196:197], v227 offset:24576
  ds_read_b64_tr_b16 v[198:199], v227 offset:26624
  ds_read_b64_tr_b16 v[200:201], v228 offset:24576
  ds_read_b64_tr_b16 v[202:203], v228 offset:26624
  ds_read_b64_tr_b16 v[204:205], v229 offset:24576
  ds_read_b64_tr_b16 v[206:207], v229 offset:26624
  v_mfma_f32_32x32x16_bf16 v[144:159], v[212:215], v[36:39], v[144:159]
  buffer_load_dwordx4 v[72:75], v2, s[36:39], s5 offen offset:2048 sc1
  v_mfma_f32_32x32x16_bf16 v[160:175], v[216:219], v[36:39], v[160:175]
  v_mfma_f32_32x32x16_bf16 v[176:191], v[220:223], v[36:39], v[176:191]
  s_waitcnt lgkmcnt(0)
  s_waitcnt vmcnt(16)
  v_mfma_f32_32x32x16_bf16 v[128:143], v[192:195], v[40:43], v[128:143]
  ds_read_b64_tr_b16 v[208:209], v226 offset:28672
  ds_read_b64_tr_b16 v[210:211], v226 offset:30720
  ds_read_b64_tr_b16 v[212:213], v227 offset:28672
  ds_read_b64_tr_b16 v[214:215], v227 offset:30720
  ds_read_b64_tr_b16 v[216:217], v228 offset:28672
  ds_read_b64_tr_b16 v[218:219], v228 offset:30720
  ds_read_b64_tr_b16 v[220:221], v229 offset:28672
  ds_read_b64_tr_b16 v[222:223], v229 offset:30720
  v_mfma_f32_32x32x16_bf16 v[144:159], v[196:199], v[40:43], v[144:159]
  buffer_load_dwordx4 v[76:79], v2, s[36:39], s5 offen offset:3072 sc1
  v_mfma_f32_32x32x16_bf16 v[160:175], v[200:203], v[40:43], v[160:175]
  s_add_u32 s82, s3, 86016
  buffer_load_dwordx4 a[48:51], v2, s[36:39], s82 offen offset:0 sc1
  buffer_load_dwordx4 a[52:55], v2, s[36:39], s82 offen offset:1024 sc1
  v_mfma_f32_32x32x16_bf16 v[176:191], v[204:207], v[40:43], v[176:191]
  s_waitcnt vmcnt(13)
  v_mfma_f32_32x32x16_bf16 v[128:143], v[112:115], v[234:237], v[128:143]
  v_mfma_f32_32x32x16_bf16 v[144:159], v[116:119], v[234:237], v[144:159]
  v_mfma_f32_32x32x16_bf16 v[160:175], v[120:123], v[234:237], v[160:175]
  v_mfma_f32_32x32x16_bf16 v[176:191], v[124:127], v[234:237], v[176:191]
  s_waitcnt lgkmcnt(0)
  v_mfma_f32_32x32x16_bf16 v[128:143], v[208:211], v[44:47], v[128:143]
  ds_read_b64_tr_b16 v[192:193], v226 offset:32768
  ds_read_b64_tr_b16 v[194:195], v226 offset:34816
  ds_read_b64_tr_b16 v[196:197], v227 offset:32768
  ds_read_b64_tr_b16 v[198:199], v227 offset:34816
  ds_read_b64_tr_b16 v[200:201], v228 offset:32768
  ds_read_b64_tr_b16 v[202:203], v228 offset:34816
  ds_read_b64_tr_b16 v[204:205], v229 offset:32768
  ds_read_b64_tr_b16 v[206:207], v229 offset:34816
  v_mfma_f32_32x32x16_bf16 v[144:159], v[212:215], v[44:47], v[144:159]
  s_add_u32 s5, s91, 16384
  buffer_load_dwordx4 v[80:83], v2, s[36:39], s5 offen offset:0 sc1
  v_mfma_f32_32x32x16_bf16 v[160:175], v[216:219], v[44:47], v[160:175]
  v_mfma_f32_32x32x16_bf16 v[176:191], v[220:223], v[44:47], v[176:191]
  s_waitcnt lgkmcnt(0)
  v_mfma_f32_32x32x16_bf16 v[128:143], v[192:195], v[48:51], v[128:143]
  ds_read_b64_tr_b16 v[208:209], v226 offset:36864
  ds_read_b64_tr_b16 v[210:211], v226 offset:38912
  ds_read_b64_tr_b16 v[212:213], v227 offset:36864
  ds_read_b64_tr_b16 v[214:215], v227 offset:38912
  ds_read_b64_tr_b16 v[216:217], v228 offset:36864
  ds_read_b64_tr_b16 v[218:219], v228 offset:38912
  ds_read_b64_tr_b16 v[220:221], v229 offset:36864
  ds_read_b64_tr_b16 v[222:223], v229 offset:38912
  v_mfma_f32_32x32x16_bf16 v[144:159], v[196:199], v[48:51], v[144:159]
  buffer_load_dwordx4 v[84:87], v2, s[36:39], s5 offen offset:1024 sc1
  v_mfma_f32_32x32x16_bf16 v[160:175], v[200:203], v[48:51], v[160:175]
  s_add_u32 s82, s87, 1
  s_and_b32 s82, s82, 3
  s_mul_i32 s82, s82, 100352
  s_add_u32 s3, s73, s82
  s_add_u32 s82, s3, 0
  buffer_load_dwordx4 a[56:59], v2, s[36:39], s82 offen offset:0 sc1
  buffer_load_dwordx4 a[60:63], v2, s[36:39], s82 offen offset:1024 sc1
  v_mfma_f32_32x32x16_bf16 v[176:191], v[204:207], v[48:51], v[176:191]
  s_waitcnt lgkmcnt(0)
  s_waitcnt vmcnt(16)
  v_mfma_f32_32x32x16_bf16 v[128:143], v[208:211], v[52:55], v[128:143]
  ds_read_b64_tr_b16 v[192:193], v226 offset:40960
  ds_read_b64_tr_b16 v[194:195], v226 offset:43008
  ds_read_b64_tr_b16 v[196:197], v227 offset:40960
  ds_read_b64_tr_b16 v[198:199], v227 offset:43008
  ds_read_b64_tr_b16 v[200:201], v228 offset:40960
  ds_read_b64_tr_b16 v[202:203], v228 offset:43008
  ds_read_b64_tr_b16 v[204:205], v229 offset:40960
  ds_read_b64_tr_b16 v[206:207], v229 offset:43008
  v_mfma_f32_32x32x16_bf16 v[144:159], v[212:215], v[52:55], v[144:159]
  buffer_load_dwordx4 v[88:91], v2, s[36:39], s5 offen offset:2048 sc1
  v_mfma_f32_32x32x16_bf16 v[160:175], v[216:219], v[52:55], v[160:175]
  v_mfma_f32_32x32x16_bf16 v[176:191], v[220:223], v[52:55], v[176:191]
  s_waitcnt lgkmcnt(0)
  s_waitcnt vmcnt(16)
  v_mfma_f32_32x32x16_bf16 v[128:143], v[192:195], v[56:59], v[128:143]
  ds_read_b64_tr_b16 v[208:209], v226 offset:45056
  ds_read_b64_tr_b16 v[210:211], v226 offset:47104
  ds_read_b64_tr_b16 v[212:213], v227 offset:45056
  ds_read_b64_tr_b16 v[214:215], v227 offset:47104
  ds_read_b64_tr_b16 v[216:217], v228 offset:45056
  ds_read_b64_tr_b16 v[218:219], v228 offset:47104
  ds_read_b64_tr_b16 v[220:221], v229 offset:45056
  ds_read_b64_tr_b16 v[222:223], v229 offset:47104
  v_mfma_f32_32x32x16_bf16 v[144:159], v[196:199], v[56:59], v[144:159]
  buffer_load_dwordx4 v[92:95], v2, s[36:39], s5 offen offset:3072 sc1
  v_mfma_f32_32x32x16_bf16 v[160:175], v[200:203], v[56:59], v[160:175]
  s_add_u32 s82, s3, 14336
  buffer_load_dwordx4 a[64:67], v2, s[36:39], s82 offen offset:0 sc1
  buffer_load_dwordx4 a[68:71], v2, s[36:39], s82 offen offset:1024 sc1
  v_mfma_f32_32x32x16_bf16 v[176:191], v[204:207], v[56:59], v[176:191]
  s_waitcnt lgkmcnt(0)
  s_waitcnt vmcnt(18)
  v_mfma_f32_32x32x16_bf16 v[128:143], v[208:211], v[60:63], v[128:143]
  ds_read_b64_tr_b16 v[192:193], v226 offset:49152
  ds_read_b64_tr_b16 v[194:195], v226 offset:51200
  ds_read_b64_tr_b16 v[196:197], v227 offset:49152
  ds_read_b64_tr_b16 v[198:199], v227 offset:51200
  ds_read_b64_tr_b16 v[200:201], v228 offset:49152
  ds_read_b64_tr_b16 v[202:203], v228 offset:51200
  ds_read_b64_tr_b16 v[204:205], v229 offset:49152
  ds_read_b64_tr_b16 v[206:207], v229 offset:51200
  v_mfma_f32_32x32x16_bf16 v[144:159], v[212:215], v[60:63], v[144:159]
  s_add_u32 s5, s91, 20480
  buffer_load_dwordx4 v[96:99], v2, s[36:39], s5 offen offset:0 sc1
  v_mfma_f32_32x32x16_bf16 v[160:175], v[216:219], v[60:63], v[160:175]
  v_mfma_f32_32x32x16_bf16 v[176:191], v[220:223], v[60:63], v[176:191]
  s_waitcnt lgkmcnt(0)
  s_waitcnt vmcnt(16)
  v_mfma_f32_32x32x16_bf16 v[128:143], v[192:195], v[64:67], v[128:143]
  ds_read_b64_tr_b16 v[208:209], v226 offset:53248
  ds_read_b64_tr_b16 v[210:211], v226 offset:55296
  ds_read_b64_tr_b16 v[212:213], v227 offset:53248
  ds_read_b64_tr_b16 v[214:215], v227 offset:55296
  ds_read_b64_tr_b16 v[216:217], v228 offset:53248
  ds_read_b64_tr_b16 v[218:219], v228 offset:55296
  ds_read_b64_tr_b16 v[220:221], v229 offset:53248
  ds_read_b64_tr_b16 v[222:223], v229 offset:55296
  v_mfma_f32_32x32x16_bf16 v[144:159], v[196:199], v[64:67], v[144:159]
  buffer_load_dwordx4 v[100:103], v2, s[36:39], s5 offen offset:1024 sc1
  v_mfma_f32_32x32x16_bf16 v[160:175], v[200:203], v[64:67], v[160:175]
  s_add_u32 s82, s3, 28672
  buffer_load_dwordx4 a[72:75], v2, s[36:39], s82 offen offset:0 sc1
  buffer_load_dwordx4 a[76:79], v2, s[36:39], s82 offen offset:1024 sc1
  v_mfma_f32_32x32x16_bf16 v[176:191], v[204:207], v[64:67], v[176:191]
  s_waitcnt lgkmcnt(0)
  s_waitcnt vmcnt(18)
  v_mfma_f32_32x32x16_bf16 v[128:143], v[208:211], v[68:71], v[128:143]
  ds_read_b64_tr_b16 v[192:193], v226 offset:57344
  ds_read_b64_tr_b16 v[194:195], v226 offset:59392
  ds_read_b64_tr_b16 v[196:197], v227 offset:57344
  ds_read_b64_tr_b16 v[198:199], v227 offset:59392
  ds_read_b64_tr_b16 v[200:201], v228 offset:57344
  ds_read_b64_tr_b16 v[202:203], v228 offset:59392
  ds_read_b64_tr_b16 v[204:205], v229 offset:57344
  ds_read_b64_tr_b16 v[206:207], v229 offset:59392
  v_mfma_f32_32x32x16_bf16 v[144:159], v[212:215], v[68:71], v[144:159]
  buffer_load_dwordx4 v[104:107], v2, s[36:39], s5 offen offset:2048 sc1
  v_mfma_f32_32x32x16_bf16 v[160:175], v[216:219], v[68:71], v[160:175]
  v_mfma_f32_32x32x16_bf16 v[176:191], v[220:223], v[68:71], v[176:191]
  s_waitcnt lgkmcnt(0)
  s_waitcnt vmcnt(16)
  v_mfma_f32_32x32x16_bf16 v[128:143], v[192:195], v[72:75], v[128:143]
  ds_read_b64_tr_b16 v[208:209], v226 offset:61440
  ds_read_b64_tr_b16 v[210:211], v226 offset:63488
  ds_read_b64_tr_b16 v[212:213], v227 offset:61440
  ds_read_b64_tr_b16 v[214:215], v227 offset:63488
  ds_read_b64_tr_b16 v[216:217], v228 offset:61440
  ds_read_b64_tr_b16 v[218:219], v228 offset:63488
  ds_read_b64_tr_b16 v[220:221], v229 offset:61440
  ds_read_b64_tr_b16 v[222:223], v229 offset:63488
  v_mfma_f32_32x32x16_bf16 v[144:159], v[196:199], v[72:75], v[144:159]
  buffer_load_dwordx4 v[108:111], v2, s[36:39], s5 offen offset:3072 sc1
  v_mfma_f32_32x32x16_bf16 v[160:175], v[200:203], v[72:75], v[160:175]
  s_add_u32 s82, s3, 43008
  buffer_load_dwordx4 a[80:83], v2, s[36:39], s82 offen offset:0 sc1
  buffer_load_dwordx4 a[84:87], v2, s[36:39], s82 offen offset:1024 sc1
  v_mfma_f32_32x32x16_bf16 v[176:191], v[204:207], v[72:75], v[176:191]
  s_waitcnt lgkmcnt(0)
  s_waitcnt vmcnt(18)
  v_mfma_f32_32x32x16_bf16 v[128:143], v[208:211], v[76:79], v[128:143]
  ds_read_b64_tr_b16 v[192:193], v230 offset:0
  ds_read_b64_tr_b16 v[194:195], v230 offset:2048
  ds_read_b64_tr_b16 v[196:197], v231 offset:0
  ds_read_b64_tr_b16 v[198:199], v231 offset:2048
  ds_read_b64_tr_b16 v[200:201], v232 offset:0
  ds_read_b64_tr_b16 v[202:203], v232 offset:2048
  ds_read_b64_tr_b16 v[204:205], v233 offset:0
  ds_read_b64_tr_b16 v[206:207], v233 offset:2048
  v_mfma_f32_32x32x16_bf16 v[144:159], v[212:215], v[76:79], v[144:159]
  s_add_u32 s5, s91, 24576
  buffer_load_dwordx4 v[112:115], v2, s[36:39], s5 offen offset:0 sc1
  v_mfma_f32_32x32x16_bf16 v[160:175], v[216:219], v[76:79], v[160:175]
  v_mfma_f32_32x32x16_bf16 v[176:191], v[220:223], v[76:79], v[176:191]
  s_waitcnt lgkmcnt(0)
  s_waitcnt vmcnt(16)
  v_mfma_f32_32x32x16_bf16 v[128:143], v[192:195], v[80:83], v[128:143]
  ds_read_b64_tr_b16 v[208:209], v230 offset:4096
  ds_read_b64_tr_b16 v[210:211], v230 offset:6144
  ds_read_b64_tr_b16 v[212:213], v231 offset:4096
  ds_read_b64_tr_b16 v[214:215], v231 offset:6144
  ds_read_b64_tr_b16 v[216:217], v232 offset:4096
  ds_read_b64_tr_b16 v[218:219], v232 offset:6144
  ds_read_b64_tr_b16 v[220:221], v233 offset:4096
  ds_read_b64_tr_b16 v[222:223], v233 offset:6144
  v_mfma_f32_32x32x16_bf16 v[144:159], v[196:199], v[80:83], v[144:159]
  buffer_load_dwordx4 v[116:119], v2, s[36:39], s5 offen offset:1024 sc1
  v_mfma_f32_32x32x16_bf16 v[160:175], v[200:203], v[80:83], v[160:175]
  s_add_u32 s82, s3, 57344
  buffer_load_dwordx4 a[88:91], v2, s[36:39], s82 offen offset:0 sc1
  buffer_load_dwordx4 a[92:95], v2, s[36:39], s82 offen offset:1024 sc1
  v_mfma_f32_32x32x16_bf16 v[176:191], v[204:207], v[80:83], v[176:191]
  s_waitcnt lgkmcnt(0)
  s_waitcnt vmcnt(18)
  v_mfma_f32_32x32x16_bf16 v[128:143], v[208:211], v[84:87], v[128:143]
  ds_read_b64_tr_b16 v[192:193], v230 offset:8192
  ds_read_b64_tr_b16 v[194:195], v230 offset:10240
  ds_read_b64_tr_b16 v[196:197], v231 offset:8192
  ds_read_b64_tr_b16 v[198:199], v231 offset:10240
  ds_read_b64_tr_b16 v[200:201], v232 offset:8192
  ds_read_b64_tr_b16 v[202:203], v232 offset:10240
  ds_read_b64_tr_b16 v[204:205], v233 offset:8192
  ds_read_b64_tr_b16 v[206:207], v233 offset:10240
  v_mfma_f32_32x32x16_bf16 v[144:159], v[212:215], v[84:87], v[144:159]
  buffer_load_dwordx4 v[120:123], v2, s[36:39], s5 offen offset:2048 sc1
  v_mfma_f32_32x32x16_bf16 v[160:175], v[216:219], v[84:87], v[160:175]
  v_mfma_f32_32x32x16_bf16 v[176:191], v[220:223], v[84:87], v[176:191]
  s_waitcnt lgkmcnt(0)
  s_waitcnt vmcnt(16)
  v_mfma_f32_32x32x16_bf16 v[128:143], v[192:195], v[88:91], v[128:143]
  ds_read_b64_tr_b16 v[208:209], v230 offset:12288
  ds_read_b64_tr_b16 v[210:211], v230 offset:14336
  ds_read_b64_tr_b16 v[212:213], v231 offset:12288
  ds_read_b64_tr_b16 v[214:215], v231 offset:14336
  ds_read_b64_tr_b16 v[216:217], v232 offset:12288
  ds_read_b64_tr_b16 v[218:219], v232 offset:14336
  ds_read_b64_tr_b16 v[220:221], v233 offset:12288
  ds_read_b64_tr_b16 v[222:223], v233 offset:14336
  v_mfma_f32_32x32x16_bf16 v[144:159], v[196:199], v[88:91], v[144:159]
  buffer_load_dwordx4 v[124:127], v2, s[36:39], s5 offen offset:3072 sc1
  v_mfma_f32_32x32x16_bf16 v[160:175], v[200:203], v[88:91], v[160:175]
  s_add_u32 s82, s3, 71680
  buffer_load_dwordx4 a[96:99], v2, s[36:39], s82 offen offset:0 sc1
  buffer_load_dwordx4 a[100:103], v2, s[36:39], s82 offen offset:1024 sc1
  v_mfma_f32_32x32x16_bf16 v[176:191], v[204:207], v[88:91], v[176:191]
  s_waitcnt lgkmcnt(0)
  s_waitcnt vmcnt(18)
  v_mfma_f32_32x32x16_bf16 v[128:143], v[208:211], v[92:95], v[128:143]
  ds_read_b64_tr_b16 v[192:193], v230 offset:16384
  ds_read_b64_tr_b16 v[194:195], v230 offset:18432
  ds_read_b64_tr_b16 v[196:197], v231 offset:16384
  ds_read_b64_tr_b16 v[198:199], v231 offset:18432
  ds_read_b64_tr_b16 v[200:201], v232 offset:16384
  ds_read_b64_tr_b16 v[202:203], v232 offset:18432
  ds_read_b64_tr_b16 v[204:205], v233 offset:16384
  ds_read_b64_tr_b16 v[206:207], v233 offset:18432
  v_mfma_f32_32x32x16_bf16 v[144:159], v[212:215], v[92:95], v[144:159]
  v_mfma_f32_32x32x16_bf16 v[160:175], v[216:219], v[92:95], v[160:175]
  s_add_u32 s82, s3, 86016
  buffer_load_dwordx4 a[104:107], v2, s[36:39], s82 offen offset:0 sc1
  buffer_load_dwordx4 a[108:111], v2, s[36:39], s82 offen offset:1024 sc1
  v_mfma_f32_32x32x16_bf16 v[176:191], v[220:223], v[92:95], v[176:191]
  s_waitcnt lgkmcnt(0)
  s_waitcnt vmcnt(17)
  v_mfma_f32_32x32x16_bf16 v[128:143], v[192:195], v[96:99], v[128:143]
  ds_read_b64_tr_b16 v[208:209], v230 offset:20480
  ds_read_b64_tr_b16 v[210:211], v230 offset:22528
  ds_read_b64_tr_b16 v[212:213], v231 offset:20480
  ds_read_b64_tr_b16 v[214:215], v231 offset:22528
  ds_read_b64_tr_b16 v[216:217], v232 offset:20480
  ds_read_b64_tr_b16 v[218:219], v232 offset:22528
  ds_read_b64_tr_b16 v[220:221], v233 offset:20480
  ds_read_b64_tr_b16 v[222:223], v233 offset:22528
  v_mfma_f32_32x32x16_bf16 v[144:159], v[196:199], v[96:99], v[144:159]
  v_mfma_f32_32x32x16_bf16 v[160:175], v[200:203], v[96:99], v[160:175]
  s_add_u32 s82, s87, 2
  s_and_b32 s82, s82, 3
  s_mul_i32 s82, s82, 100352
  s_add_u32 s3, s73, s82
  s_add_u32 s82, s3, 0
  buffer_load_dwordx4 a[112:115], v2, s[36:39], s82 offen offset:0 sc1
  buffer_load_dwordx4 a[116:119], v2, s[36:39], s82 offen offset:1024 sc1
  v_mfma_f32_32x32x16_bf16 v[176:191], v[204:207], v[96:99], v[176:191]
  s_waitcnt lgkmcnt(0)
  s_waitcnt vmcnt(18)
  v_mfma_f32_32x32x16_bf16 v[128:143], v[208:211], v[100:103], v[128:143]
  ds_read_b64_tr_b16 v[192:193], v230 offset:24576
  ds_read_b64_tr_b16 v[194:195], v230 offset:26624
  ds_read_b64_tr_b16 v[196:197], v231 offset:24576
  ds_read_b64_tr_b16 v[198:199], v231 offset:26624
  ds_read_b64_tr_b16 v[200:201], v232 offset:24576
  ds_read_b64_tr_b16 v[202:203], v232 offset:26624
  ds_read_b64_tr_b16 v[204:205], v233 offset:24576
  ds_read_b64_tr_b16 v[206:207], v233 offset:26624
  v_mfma_f32_32x32x16_bf16 v[144:159], v[212:215], v[100:103], v[144:159]
  v_mfma_f32_32x32x16_bf16 v[160:175], v[216:219], v[100:103], v[160:175]
  s_add_u32 s82, s3, 14336
  buffer_load_dwordx4 a[120:123], v2, s[36:39], s82 offen offset:0 sc1
  buffer_load_dwordx4 a[124:127], v2, s[36:39], s82 offen offset:1024 sc1
  v_mfma_f32_32x32x16_bf16 v[176:191], v[220:223], v[100:103], v[176:191]
  s_waitcnt lgkmcnt(0)
  s_waitcnt vmcnt(17)
  v_mfma_f32_32x32x16_bf16 v[128:143], v[192:195], v[104:107], v[128:143]
  ds_read_b64_tr_b16 v[208:209], v230 offset:28672
  ds_read_b64_tr_b16 v[210:211], v230 offset:30720
  ds_read_b64_tr_b16 v[212:213], v231 offset:28672
  ds_read_b64_tr_b16 v[214:215], v231 offset:30720
  ds_read_b64_tr_b16 v[216:217], v232 offset:28672
  ds_read_b64_tr_b16 v[218:219], v232 offset:30720
  ds_read_b64_tr_b16 v[220:221], v233 offset:28672
  ds_read_b64_tr_b16 v[222:223], v233 offset:30720
  v_mfma_f32_32x32x16_bf16 v[144:159], v[196:199], v[104:107], v[144:159]
  v_mfma_f32_32x32x16_bf16 v[160:175], v[200:203], v[104:107], v[160:175]
  s_add_u32 s82, s3, 28672
  buffer_load_dwordx4 a[128:131], v2, s[36:39], s82 offen offset:0 sc1
  buffer_load_dwordx4 a[132:135], v2, s[36:39], s82 offen offset:1024 sc1
  v_mfma_f32_32x32x16_bf16 v[176:191], v[204:207], v[104:107], v[176:191]
  s_waitcnt lgkmcnt(0)
  s_waitcnt vmcnt(18)
  v_mfma_f32_32x32x16_bf16 v[128:143], v[208:211], v[108:111], v[128:143]
  ds_read_b64_tr_b16 v[192:193], v230 offset:32768
  ds_read_b64_tr_b16 v[194:195], v230 offset:34816
  ds_read_b64_tr_b16 v[196:197], v231 offset:32768
  ds_read_b64_tr_b16 v[198:199], v231 offset:34816
  ds_read_b64_tr_b16 v[200:201], v232 offset:32768
  ds_read_b64_tr_b16 v[202:203], v232 offset:34816
  ds_read_b64_tr_b16 v[204:205], v233 offset:32768
  ds_read_b64_tr_b16 v[206:207], v233 offset:34816
  v_mfma_f32_32x32x16_bf16 v[144:159], v[212:215], v[108:111], v[144:159]
  v_mfma_f32_32x32x16_bf16 v[160:175], v[216:219], v[108:111], v[160:175]
  s_add_u32 s82, s3, 43008
  buffer_load_dwordx4 a[136:139], v2, s[36:39], s82 offen offset:0 sc1
  buffer_load_dwordx4 a[140:143], v2, s[36:39], s82 offen offset:1024 sc1
  v_mfma_f32_32x32x16_bf16 v[176:191], v[220:223], v[108:111], v[176:191]
  s_waitcnt lgkmcnt(0)
  s_waitcnt vmcnt(17)
  v_mfma_f32_32x32x16_bf16 v[128:143], v[192:195], v[112:115], v[128:143]
  ds_read_b64_tr_b16 v[208:209], v230 offset:36864
  ds_read_b64_tr_b16 v[210:211], v230 offset:38912
  ds_read_b64_tr_b16 v[212:213], v231 offset:36864
  ds_read_b64_tr_b16 v[214:215], v231 offset:38912
  ds_read_b64_tr_b16 v[216:217], v232 offset:36864
  ds_read_b64_tr_b16 v[218:219], v232 offset:38912
  ds_read_b64_tr_b16 v[220:221], v233 offset:36864
  ds_read_b64_tr_b16 v[222:223], v233 offset:38912
  v_mfma_f32_32x32x16_bf16 v[144:159], v[196:199], v[112:115], v[144:159]
  v_mfma_f32_32x32x16_bf16 v[160:175], v[200:203], v[112:115], v[160:175]
  s_add_u32 s82, s3, 57344
  buffer_load_dwordx4 a[144:147], v2, s[36:39], s82 offen offset:0 sc1
  buffer_load_dwordx4 a[148:151], v2, s[36:39], s82 offen offset:1024 sc1
  v_mfma_f32_32x32x16_bf16 v[176:191], v[204:207], v[112:115], v[176:191]
  s_waitcnt lgkmcnt(0)
  s_waitcnt vmcnt(18)
  v_mfma_f32_32x32x16_bf16 v[128:143], v[208:211], v[116:119], v[128:143]
  ds_read_b64_tr_b16 v[192:193], v230 offset:40960
  ds_read_b64_tr_b16 v[194:195], v230 offset:43008
  ds_read_b64_tr_b16 v[196:197], v231 offset:40960
  ds_read_b64_tr_b16 v[198:199], v231 offset:43008
  ds_read_b64_tr_b16 v[200:201], v232 offset:40960
  ds_read_b64_tr_b16 v[202:203], v232 offset:43008
  ds_read_b64_tr_b16 v[204:205], v233 offset:40960
  ds_read_b64_tr_b16 v[206:207], v233 offset:43008
  v_mfma_f32_32x32x16_bf16 v[144:159], v[212:215], v[116:119], v[144:159]
  v_mfma_f32_32x32x16_bf16 v[160:175], v[216:219], v[116:119], v[160:175]
  s_add_u32 s82, s3, 71680
  buffer_load_dwordx4 a[152:155], v2, s[36:39], s82 offen offset:0 sc1
  buffer_load_dwordx4 a[156:159], v2, s[36:39], s82 offen offset:1024 sc1
  v_mfma_f32_32x32x16_bf16 v[176:191], v[220:223], v[116:119], v[176:191]
  s_waitcnt lgkmcnt(0)
  s_waitcnt vmcnt(17)
  v_mfma_f32_32x32x16_bf16 v[128:143], v[192:195], v[120:123], v[128:143]
  ds_read_b64_tr_b16 v[208:209], v230 offset:45056
  ds_read_b64_tr_b16 v[210:211], v230 offset:47104
  ds_read_b64_tr_b16 v[212:213], v231 offset:45056
  ds_read_b64_tr_b16 v[214:215], v231 offset:47104
  ds_read_b64_tr_b16 v[216:217], v232 offset:45056
  ds_read_b64_tr_b16 v[218:219], v232 offset:47104
  ds_read_b64_tr_b16 v[220:221], v233 offset:45056
  ds_read_b64_tr_b16 v[222:223], v233 offset:47104
  v_mfma_f32_32x32x16_bf16 v[144:159], v[196:199], v[120:123], v[144:159]
  v_mfma_f32_32x32x16_bf16 v[160:175], v[200:203], v[120:123], v[160:175]
  s_add_u32 s82, s3, 86016
  buffer_load_dwordx4 a[160:163], v2, s[36:39], s82 offen offset:0 sc1
  buffer_load_dwordx4 a[164:167], v2, s[36:39], s82 offen offset:1024 sc1
  v_mfma_f32_32x32x16_bf16 v[176:191], v[204:207], v[120:123], v[176:191]
  s_waitcnt lgkmcnt(0)
  s_waitcnt vmcnt(18)
  v_mfma_f32_32x32x16_bf16 v[128:143], v[208:211], v[124:127], v[128:143]
  v_mfma_f32_32x32x16_bf16 v[144:159], v[212:215], v[124:127], v[144:159]
  v_mfma_f32_32x32x16_bf16 v[160:175], v[216:219], v[124:127], v[160:175]
  s_add_u32 s82, s87, 3
  s_and_b32 s82, s82, 3
  s_mul_i32 s82, s82, 100352
  s_add_u32 s3, s73, s82
  s_add_u32 s82, s3, 0
  buffer_load_dwordx4 a[168:171], v2, s[36:39], s82 offen offset:0 sc1
  buffer_load_dwordx4 a[172:175], v2, s[36:39], s82 offen offset:1024 sc1
  v_mfma_f32_32x32x16_bf16 v[176:191], v[220:223], v[124:127], v[176:191]
  s_nop 1
  v_pk_mul_f32 v[16:17], v[128:129], v[128:129]
  v_pk_mul_f32 v[18:19], v[130:131], v[130:131]
  v_pk_mul_f32 v[20:21], v[132:133], v[132:133]
  v_pk_mul_f32 v[22:23], v[134:135], v[134:135]
  v_pk_mul_f32 v[24:25], v[136:137], v[136:137]
  v_pk_mul_f32 v[26:27], v[138:139], v[138:139]
  v_pk_mul_f32 v[28:29], v[140:141], v[140:141]
  v_pk_mul_f32 v[30:31], v[142:143], v[142:143]
  v_pk_fma_f32 v[16:17], v[16:17], v[252:253], v[250:251]
  v_pk_fma_f32 v[18:19], v[18:19], v[252:253], v[250:251]
  v_pk_fma_f32 v[20:21], v[20:21], v[252:253], v[250:251]
  v_pk_fma_f32 v[22:23], v[22:23], v[252:253], v[250:251]
  v_pk_fma_f32 v[24:25], v[24:25], v[252:253], v[250:251]
  v_pk_fma_f32 v[26:27], v[26:27], v[252:253], v[250:251]
  v_pk_fma_f32 v[28:29], v[28:29], v[252:253], v[250:251]
  v_pk_fma_f32 v[30:31], v[30:31], v[252:253], v[250:251]
  v_pk_mul_f32 v[16:17], v[16:17], v[128:129]
  v_pk_mul_f32 v[18:19], v[18:19], v[130:131]
  v_pk_mul_f32 v[20:21], v[20:21], v[132:133]
  v_pk_mul_f32 v[22:23], v[22:23], v[134:135]
  v_pk_mul_f32 v[24:25], v[24:25], v[136:137]
  v_pk_mul_f32 v[26:27], v[26:27], v[138:139]
  v_pk_mul_f32 v[28:29], v[28:29], v[140:141]
  v_pk_mul_f32 v[30:31], v[30:31], v[142:143]
  s_add_u32 s82, s3, 14336
  buffer_load_dwordx4 a[176:179], v2, s[36:39], s82 offen offset:0 sc1
  buffer_load_dwordx4 a[180:183], v2, s[36:39], s82 offen offset:1024 sc1
  v_exp_f32 v16, v16
  v_exp_f32 v17, v17
  v_exp_f32 v18, v18
  v_exp_f32 v19, v19
  v_exp_f32 v20, v20
  v_exp_f32 v21, v21
  v_exp_f32 v22, v22
  v_exp_f32 v23, v23
  v_exp_f32 v24, v24
  v_exp_f32 v25, v25
  v_exp_f32 v26, v26
  v_exp_f32 v27, v27
  v_exp_f32 v28, v28
  v_exp_f32 v29, v29
  v_exp_f32 v30, v30
  v_exp_f32 v31, v31
  s_add_u32 s82, s3, 28672
  buffer_load_dwordx4 a[184:187], v2, s[36:39], s82 offen offset:0 sc1
  buffer_load_dwordx4 a[188:191], v2, s[36:39], s82 offen offset:1024 sc1
  v_pk_fma_f32 v[16:17], v[16:17], v[254:255], v[254:255]
  v_pk_fma_f32 v[18:19], v[18:19], v[254:255], v[254:255]
  v_pk_fma_f32 v[20:21], v[20:21], v[254:255], v[254:255]
  v_pk_fma_f32 v[22:23], v[22:23], v[254:255], v[254:255]
  v_pk_fma_f32 v[24:25], v[24:25], v[254:255], v[254:255]
  v_pk_fma_f32 v[26:27], v[26:27], v[254:255], v[254:255]
  v_pk_fma_f32 v[28:29], v[28:29], v[254:255], v[254:255]
  v_pk_fma_f32 v[30:31], v[30:31], v[254:255], v[254:255]
  v_rcp_f32 v16, v16
  v_rcp_f32 v17, v17
  v_rcp_f32 v18, v18
  v_rcp_f32 v19, v19
  v_rcp_f32 v20, v20
  v_rcp_f32 v21, v21
  v_rcp_f32 v22, v22
  v_rcp_f32 v23, v23
  v_rcp_f32 v24, v24
  v_rcp_f32 v25, v25
  v_rcp_f32 v26, v26
  v_rcp_f32 v27, v27
  v_rcp_f32 v28, v28
  v_rcp_f32 v29, v29
  v_rcp_f32 v30, v30
  v_rcp_f32 v31, v31
  v_pk_mul_f32 v[128:129], v[128:129], v[16:17]
  v_pk_mul_f32 v[130:131], v[130:131], v[18:19]
  v_pk_mul_f32 v[132:133], v[132:133], v[20:21]
  v_pk_mul_f32 v[134:135], v[134:135], v[22:23]
  v_pk_mul_f32 v[136:137], v[136:137], v[24:25]
  v_pk_mul_f32 v[138:139], v[138:139], v[26:27]
  v_pk_mul_f32 v[140:141], v[140:141], v[28:29]
  v_pk_mul_f32 v[142:143], v[142:143], v[30:31]
  v_cvt_pk_bf16_f32 v128, v128, v129
  v_cvt_pk_bf16_f32 v129, v130, v131
  v_cvt_pk_bf16_f32 v130, v132, v133
  v_cvt_pk_bf16_f32 v131, v134, v135
  v_cvt_pk_bf16_f32 v132, v136, v137
  v_cvt_pk_bf16_f32 v133, v138, v139
  v_cvt_pk_bf16_f32 v134, v140, v141
  v_cvt_pk_bf16_f32 v135, v142, v143
  s_add_u32 s81, s90, 0
  buffer_store_dwordx4 v[128:131], v2, s[36:39], s81 offen offset:0 sc1
  buffer_store_dwordx4 v[132:135], v2, s[36:39], s81 offen offset:1024 sc1
  v_pk_mul_f32 v[32:33], v[144:145], v[144:145]
  v_pk_mul_f32 v[34:35], v[146:147], v[146:147]
  v_pk_mul_f32 v[36:37], v[148:149], v[148:149]
  v_pk_mul_f32 v[38:39], v[150:151], v[150:151]
  v_pk_mul_f32 v[40:41], v[152:153], v[152:153]
  v_pk_mul_f32 v[42:43], v[154:155], v[154:155]
  v_pk_mul_f32 v[44:45], v[156:157], v[156:157]
  v_pk_mul_f32 v[46:47], v[158:159], v[158:159]
  v_pk_fma_f32 v[32:33], v[32:33], v[252:253], v[250:251]
  v_pk_fma_f32 v[34:35], v[34:35], v[252:253], v[250:251]
  v_pk_fma_f32 v[36:37], v[36:37], v[252:253], v[250:251]
  v_pk_fma_f32 v[38:39], v[38:39], v[252:253], v[250:251]
  v_pk_fma_f32 v[40:41], v[40:41], v[252:253], v[250:251]
  v_pk_fma_f32 v[42:43], v[42:43], v[252:253], v[250:251]
  v_pk_fma_f32 v[44:45], v[44:45], v[252:253], v[250:251]
  v_pk_fma_f32 v[46:47], v[46:47], v[252:253], v[250:251]
  v_pk_mul_f32 v[32:33], v[32:33], v[144:145]
  v_pk_mul_f32 v[34:35], v[34:35], v[146:147]
  v_pk_mul_f32 v[36:37], v[36:37], v[148:149]
  v_pk_mul_f32 v[38:39], v[38:39], v[150:151]
  v_pk_mul_f32 v[40:41], v[40:41], v[152:153]
  v_pk_mul_f32 v[42:43], v[42:43], v[154:155]
  v_pk_mul_f32 v[44:45], v[44:45], v[156:157]
  v_pk_mul_f32 v[46:47], v[46:47], v[158:159]
  s_add_u32 s82, s3, 43008
  buffer_load_dwordx4 a[192:195], v2, s[36:39], s82 offen offset:0 sc1
  buffer_load_dwordx4 a[196:199], v2, s[36:39], s82 offen offset:1024 sc1
  v_exp_f32 v32, v32
  v_exp_f32 v33, v33
  v_exp_f32 v34, v34
  v_exp_f32 v35, v35
  v_exp_f32 v36, v36
  v_exp_f32 v37, v37
  v_exp_f32 v38, v38
  v_exp_f32 v39, v39
  v_exp_f32 v40, v40
  v_exp_f32 v41, v41
  v_exp_f32 v42, v42
  v_exp_f32 v43, v43
  v_exp_f32 v44, v44
  v_exp_f32 v45, v45
  v_exp_f32 v46, v46
  v_exp_f32 v47, v47
  s_add_u32 s82, s3, 57344
  buffer_load_dwordx4 a[200:203], v2, s[36:39], s82 offen offset:0 sc1
  buffer_load_dwordx4 a[204:207], v2, s[36:39], s82 offen offset:1024 sc1
  v_pk_fma_f32 v[32:33], v[32:33], v[254:255], v[254:255]
  v_pk_fma_f32 v[34:35], v[34:35], v[254:255], v[254:255]
  v_pk_fma_f32 v[36:37], v[36:37], v[254:255], v[254:255]
  v_pk_fma_f32 v[38:39], v[38:39], v[254:255], v[254:255]
  v_pk_fma_f32 v[40:41], v[40:41], v[254:255], v[254:255]
  v_pk_fma_f32 v[42:43], v[42:43], v[254:255], v[254:255]
  v_pk_fma_f32 v[44:45], v[44:45], v[254:255], v[254:255]
  v_pk_fma_f32 v[46:47], v[46:47], v[254:255], v[254:255]
  v_rcp_f32 v32, v32
  v_rcp_f32 v33, v33
  v_rcp_f32 v34, v34
  v_rcp_f32 v35, v35
  v_rcp_f32 v36, v36
  v_rcp_f32 v37, v37
  v_rcp_f32 v38, v38
  v_rcp_f32 v39, v39
  v_rcp_f32 v40, v40
  v_rcp_f32 v41, v41
  v_rcp_f32 v42, v42
  v_rcp_f32 v43, v43
  v_rcp_f32 v44, v44
  v_rcp_f32 v45, v45
  v_rcp_f32 v46, v46
  v_rcp_f32 v47, v47
  v_pk_mul_f32 v[144:145], v[144:145], v[32:33]
  v_pk_mul_f32 v[146:147], v[146:147], v[34:35]
  v_pk_mul_f32 v[148:149], v[148:149], v[36:37]
  v_pk_mul_f32 v[150:151], v[150:151], v[38:39]
  v_pk_mul_f32 v[152:153], v[152:153], v[40:41]
  v_pk_mul_f32 v[154:155], v[154:155], v[42:43]
  v_pk_mul_f32 v[156:157], v[156:157], v[44:45]
  v_pk_mul_f32 v[158:159], v[158:159], v[46:47]
  v_cvt_pk_bf16_f32 v144, v144, v145
  v_cvt_pk_bf16_f32 v145, v146, v147
  v_cvt_pk_bf16_f32 v146, v148, v149
  v_cvt_pk_bf16_f32 v147, v150, v151
  v_cvt_pk_bf16_f32 v148, v152, v153
  v_cvt_pk_bf16_f32 v149, v154, v155
  v_cvt_pk_bf16_f32 v150, v156, v157
  v_cvt_pk_bf16_f32 v151, v158, v159
  s_add_u32 s81, s90, 2048
  buffer_store_dwordx4 v[144:147], v2, s[36:39], s81 offen offset:0 sc1
  buffer_store_dwordx4 v[148:151], v2, s[36:39], s81 offen offset:1024 sc1
  v_pk_mul_f32 v[16:17], v[160:161], v[160:161]
  v_pk_mul_f32 v[18:19], v[162:163], v[162:163]
  v_pk_mul_f32 v[20:21], v[164:165], v[164:165]
  v_pk_mul_f32 v[22:23], v[166:167], v[166:167]
  v_pk_mul_f32 v[24:25], v[168:169], v[168:169]
  v_pk_mul_f32 v[26:27], v[170:171], v[170:171]
  v_pk_mul_f32 v[28:29], v[172:173], v[172:173]
  v_pk_mul_f32 v[30:31], v[174:175], v[174:175]
  v_pk_fma_f32 v[16:17], v[16:17], v[252:253], v[250:251]
  v_pk_fma_f32 v[18:19], v[18:19], v[252:253], v[250:251]
  v_pk_fma_f32 v[20:21], v[20:21], v[252:253], v[250:251]
  v_pk_fma_f32 v[22:23], v[22:23], v[252:253], v[250:251]
  v_pk_fma_f32 v[24:25], v[24:25], v[252:253], v[250:251]
  v_pk_fma_f32 v[26:27], v[26:27], v[252:253], v[250:251]
  v_pk_fma_f32 v[28:29], v[28:29], v[252:253], v[250:251]
  v_pk_fma_f32 v[30:31], v[30:31], v[252:253], v[250:251]
  v_pk_mul_f32 v[16:17], v[16:17], v[160:161]
  v_pk_mul_f32 v[18:19], v[18:19], v[162:163]
  v_pk_mul_f32 v[20:21], v[20:21], v[164:165]
  v_pk_mul_f32 v[22:23], v[22:23], v[166:167]
  v_pk_mul_f32 v[24:25], v[24:25], v[168:169]
  v_pk_mul_f32 v[26:27], v[26:27], v[170:171]
  v_pk_mul_f32 v[28:29], v[28:29], v[172:173]
  v_pk_mul_f32 v[30:31], v[30:31], v[174:175]
  s_add_u32 s82, s3, 71680
  buffer_load_dwordx4 a[208:211], v2, s[36:39], s82 offen offset:0 sc1
  buffer_load_dwordx4 a[212:215], v2, s[36:39], s82 offen offset:1024 sc1
  v_exp_f32 v16, v16
  v_exp_f32 v17, v17
  v_exp_f32 v18, v18
  v_exp_f32 v19, v19
  v_exp_f32 v20, v20
  v_exp_f32 v21, v21
  v_exp_f32 v22, v22
  v_exp_f32 v23, v23
  v_exp_f32 v24, v24
  v_exp_f32 v25, v25
  v_exp_f32 v26, v26
  v_exp_f32 v27, v27
  v_exp_f32 v28, v28
  v_exp_f32 v29, v29
  v_exp_f32 v30, v30
  v_exp_f32 v31, v31
  s_add_u32 s82, s3, 86016
  buffer_load_dwordx4 a[216:219], v2, s[36:39], s82 offen offset:0 sc1
  buffer_load_dwordx4 a[220:223], v2, s[36:39], s82 offen offset:1024 sc1
  v_pk_fma_f32 v[16:17], v[16:17], v[254:255], v[254:255]
  v_pk_fma_f32 v[18:19], v[18:19], v[254:255], v[254:255]
  v_pk_fma_f32 v[20:21], v[20:21], v[254:255], v[254:255]
  v_pk_fma_f32 v[22:23], v[22:23], v[254:255], v[254:255]
  v_pk_fma_f32 v[24:25], v[24:25], v[254:255], v[254:255]
  v_pk_fma_f32 v[26:27], v[26:27], v[254:255], v[254:255]
  v_pk_fma_f32 v[28:29], v[28:29], v[254:255], v[254:255]
  v_pk_fma_f32 v[30:31], v[30:31], v[254:255], v[254:255]
  v_rcp_f32 v16, v16
  v_rcp_f32 v17, v17
  v_rcp_f32 v18, v18
  v_rcp_f32 v19, v19
  v_rcp_f32 v20, v20
  v_rcp_f32 v21, v21
  v_rcp_f32 v22, v22
  v_rcp_f32 v23, v23
  v_rcp_f32 v24, v24
  v_rcp_f32 v25, v25
  v_rcp_f32 v26, v26
  v_rcp_f32 v27, v27
  v_rcp_f32 v28, v28
  v_rcp_f32 v29, v29
  v_rcp_f32 v30, v30
  v_rcp_f32 v31, v31
  v_pk_mul_f32 v[160:161], v[160:161], v[16:17]
  v_pk_mul_f32 v[162:163], v[162:163], v[18:19]
  v_pk_mul_f32 v[164:165], v[164:165], v[20:21]
  v_pk_mul_f32 v[166:167], v[166:167], v[22:23]
  v_pk_mul_f32 v[168:169], v[168:169], v[24:25]
  v_pk_mul_f32 v[170:171], v[170:171], v[26:27]
  v_pk_mul_f32 v[172:173], v[172:173], v[28:29]
  v_pk_mul_f32 v[174:175], v[174:175], v[30:31]
  v_cvt_pk_bf16_f32 v160, v160, v161
  v_cvt_pk_bf16_f32 v161, v162, v163
  v_cvt_pk_bf16_f32 v162, v164, v165
  v_cvt_pk_bf16_f32 v163, v166, v167
  v_cvt_pk_bf16_f32 v164, v168, v169
  v_cvt_pk_bf16_f32 v165, v170, v171
  v_cvt_pk_bf16_f32 v166, v172, v173
  v_cvt_pk_bf16_f32 v167, v174, v175
  s_add_u32 s81, s90, 4096
  buffer_store_dwordx4 v[160:163], v2, s[36:39], s81 offen offset:0 sc1
  buffer_store_dwordx4 v[164:167], v2, s[36:39], s81 offen offset:1024 sc1
  v_pk_mul_f32 v[32:33], v[176:177], v[176:177]
  v_pk_mul_f32 v[34:35], v[178:179], v[178:179]
  v_pk_mul_f32 v[36:37], v[180:181], v[180:181]
  v_pk_mul_f32 v[38:39], v[182:183], v[182:183]
  v_pk_mul_f32 v[40:41], v[184:185], v[184:185]
  v_pk_mul_f32 v[42:43], v[186:187], v[186:187]
  v_pk_mul_f32 v[44:45], v[188:189], v[188:189]
  v_pk_mul_f32 v[46:47], v[190:191], v[190:191]
  v_pk_fma_f32 v[32:33], v[32:33], v[252:253], v[250:251]
  v_pk_fma_f32 v[34:35], v[34:35], v[252:253], v[250:251]
  v_pk_fma_f32 v[36:37], v[36:37], v[252:253], v[250:251]
  v_pk_fma_f32 v[38:39], v[38:39], v[252:253], v[250:251]
  v_pk_fma_f32 v[40:41], v[40:41], v[252:253], v[250:251]
  v_pk_fma_f32 v[42:43], v[42:43], v[252:253], v[250:251]
  v_pk_fma_f32 v[44:45], v[44:45], v[252:253], v[250:251]
  v_pk_fma_f32 v[46:47], v[46:47], v[252:253], v[250:251]
  v_pk_mul_f32 v[32:33], v[32:33], v[176:177]
  v_pk_mul_f32 v[34:35], v[34:35], v[178:179]
  v_pk_mul_f32 v[36:37], v[36:37], v[180:181]
  v_pk_mul_f32 v[38:39], v[38:39], v[182:183]
  v_pk_mul_f32 v[40:41], v[40:41], v[184:185]
  v_pk_mul_f32 v[42:43], v[42:43], v[186:187]
  v_pk_mul_f32 v[44:45], v[44:45], v[188:189]
  v_pk_mul_f32 v[46:47], v[46:47], v[190:191]
  v_exp_f32 v32, v32
  v_exp_f32 v33, v33
  v_exp_f32 v34, v34
  v_exp_f32 v35, v35
  v_exp_f32 v36, v36
  v_exp_f32 v37, v37
  v_exp_f32 v38, v38
  v_exp_f32 v39, v39
  v_exp_f32 v40, v40
  v_exp_f32 v41, v41
  v_exp_f32 v42, v42
  v_exp_f32 v43, v43
  v_exp_f32 v44, v44
  v_exp_f32 v45, v45
  v_exp_f32 v46, v46
  v_exp_f32 v47, v47
  v_pk_fma_f32 v[32:33], v[32:33], v[254:255], v[254:255]
  v_pk_fma_f32 v[34:35], v[34:35], v[254:255], v[254:255]
  v_pk_fma_f32 v[36:37], v[36:37], v[254:255], v[254:255]
  v_pk_fma_f32 v[38:39], v[38:39], v[254:255], v[254:255]
  v_pk_fma_f32 v[40:41], v[40:41], v[254:255], v[254:255]
  v_pk_fma_f32 v[42:43], v[42:43], v[254:255], v[254:255]
  v_pk_fma_f32 v[44:45], v[44:45], v[254:255], v[254:255]
  v_pk_fma_f32 v[46:47], v[46:47], v[254:255], v[254:255]
  v_rcp_f32 v32, v32
  v_rcp_f32 v33, v33
  v_rcp_f32 v34, v34
  v_rcp_f32 v35, v35
  v_rcp_f32 v36, v36
  v_rcp_f32 v37, v37
  v_rcp_f32 v38, v38
  v_rcp_f32 v39, v39
  v_rcp_f32 v40, v40
  v_rcp_f32 v41, v41
  v_rcp_f32 v42, v42
  v_rcp_f32 v43, v43
  v_rcp_f32 v44, v44
  v_rcp_f32 v45, v45
  v_rcp_f32 v46, v46
  v_rcp_f32 v47, v47
  v_pk_mul_f32 v[176:177], v[176:177], v[32:33]
  v_pk_mul_f32 v[178:179], v[178:179], v[34:35]
  v_pk_mul_f32 v[180:181], v[180:181], v[36:37]
  v_pk_mul_f32 v[182:183], v[182:183], v[38:39]
  v_pk_mul_f32 v[184:185], v[184:185], v[40:41]
  v_pk_mul_f32 v[186:187], v[186:187], v[42:43]
  v_pk_mul_f32 v[188:189], v[188:189], v[44:45]
  v_pk_mul_f32 v[190:191], v[190:191], v[46:47]
  v_cvt_pk_bf16_f32 v176, v176, v177
  v_cvt_pk_bf16_f32 v177, v178, v179
  v_cvt_pk_bf16_f32 v178, v180, v181
  v_cvt_pk_bf16_f32 v179, v182, v183
  v_cvt_pk_bf16_f32 v180, v184, v185
  v_cvt_pk_bf16_f32 v181, v186, v187
  v_cvt_pk_bf16_f32 v182, v188, v189
  v_cvt_pk_bf16_f32 v183, v190, v191
  s_add_u32 s81, s90, 6144
  buffer_store_dwordx4 v[176:179], v2, s[36:39], s81 offen offset:0 sc1
  buffer_store_dwordx4 v[180:183], v2, s[36:39], s81 offen offset:1024 sc1
  s_lshl_b32 s92, s76, 4
  s_add_u32 s92, s92, s77
  s_lshl_b32 s92, s92, 2
  s_add_u32 s92, s92, s78
  s_lshl_b32 s92, s92, 3
  s_add_u32 s92, s92, 786432
  s_waitcnt vmcnt(0)
  v_mov_b32 v14, s97
  v_mov_b32 v15, s96
  v_mov_b32 v13, 0
  s_mov_b64 s[100:101], exec
  s_mov_b64 exec, 1
  s_cmp_eq_u32 s79, 0
  s_cbranch_scc1 L_fg_26
  buffer_store_dwordx2 v[14:15], v13, s[36:39], s92 offen
  s_branch L_fe_27
L_fg_26:
  buffer_store_dwordx2 v[14:15], v13, s[36:39], s92 offen sc1
L_fe_27:
  s_mov_b64 exec, s[100:101]
  s_and_b32 s83, s78, 1
  s_lshl_b32 s84, s94, 1
  s_add_u32 s83, s83, s84
  s_lshl_b32 s83, s83, 6
  v_lshlrev_b32 v7, 3, v3
  buffer_load_dwordx2 v[80:81], v7, s[48:51], s83 offen offset:0
  buffer_load_dwordx2 v[82:83], v7, s[48:51], s83 offen offset:16
  buffer_load_dwordx2 v[84:85], v7, s[48:51], s83 offen offset:32
  buffer_load_dwordx2 v[86:87], v7, s[48:51], s83 offen offset:48
  s_cmp_lg_u32 s78, 0
  s_cbranch_scc1 L_w0_28
  v_min_u32 v13, 27, v1
  v_lshrrev_b32 v12, 1, v13
  v_lshlrev_b32 v12, 2, v12
  v_and_b32 v13, 1, v13
  v_add_u32 v12, v12, v13
  s_lshl_b32 s82, s93, 1
  v_add_u32 v12, s82, v12
  v_lshlrev_b32 v12, 3, v12
  s_lshl_b32 s92, s76, 9
  s_add_u32 s92, s92, 786432
  s_mov_b32 s88, 0
L_poll_29:
  buffer_load_dwordx2 v[14:15], v12, s[36:39], s92 offen sc1
  s_waitcnt vmcnt(0)
  v_and_b32 v13, 0xfffffff8, v14
  v_xor_b32 v13, s80, v13
  v_xor_b32 v15, s96, v15
  v_or_b32 v13, v13, v15
  v_cmp_ne_u32 vcc, 0, v13
  s_add_u32 s88, s88, 1
  s_cmp_ge_u32 s88, 0x100000
  s_cbranch_scc1 L_pd_30
  s_cmp_lg_u64 vcc, 0
  s_cbranch_scc1 L_poll_29
L_pd_30:
L_w0_28:
  s_waitcnt vmcnt(0)
  s_barrier
  s_mul_i32 s89, s95, 112
  s_mul_i32 s82, s78, 28
  s_add_u32 s89, s89, s82
  s_lshl_b32 s89, s89, 10
  s_add_u32 s89, s89, 8388608
  s_add_u32 s82, s87, 0
  s_and_b32 s82, s82, 3
  s_mul_i32 s82, s82, 7168
  s_add_u32 s5, s89, s82
  s_add_u32 s91, s5, 114688
  buffer_load_dwordx4 v[16:19], v2, s[36:39], s5 offen offset:0 sc1
  buffer_load_dwordx4 v[20:23], v2, s[36:39], s91 offen offset:0 sc1
  buffer_load_dwordx4 v[24:27], v2, s[36:39], s5 offen offset:1024 sc1
  buffer_load_dwordx4 v[28:31], v2, s[36:39], s91 offen offset:1024 sc1
  buffer_load_dwordx4 v[32:35], v2, s[36:39], s5 offen offset:2048 sc1
  buffer_load_dwordx4 v[36:39], v2, s[36:39], s91 offen offset:2048 sc1
  buffer_load_dwordx4 v[40:43], v2, s[36:39], s5 offen offset:3072 sc1
  buffer_load_dwordx4 v[44:47], v2, s[36:39], s91 offen offset:3072 sc1
  s_add_u32 s5, s5, 4096
  s_add_u32 s91, s91, 4096
  buffer_load_dwordx4 v[48:51], v2, s[36:39], s5 offen offset:0 sc1
  buffer_load_dwordx4 v[52:55], v2, s[36:39], s91 offen offset:0 sc1
  buffer_load_dwordx4 v[56:59], v2, s[36:39], s5 offen offset:1024 sc1
  buffer_load_dwordx4 v[60:63], v2, s[36:39], s91 offen offset:1024 sc1
  v_lshlrev_b32 v104, 16, v240
  v_and_b32 v105, 0xffff0000, v240
  v_lshlrev_b32 v106, 16, v241
  v_and_b32 v107, 0xffff0000, v241
  v_lshlrev_b32 v108, 16, v242
  v_and_b32 v109, 0xffff0000, v242
  v_lshlrev_b32 v110, 16, v243
  v_and_b32 v111, 0xffff0000, v243
  v_lshlrev_b32 v112, 16, v244
  v_and_b32 v113, 0xffff0000, v244
  v_lshlrev_b32 v114, 16, v245
  v_and_b32 v115, 0xffff0000, v245
  v_lshlrev_b32 v116, 16, v246
  v_and_b32 v117, 0xffff0000, v246
  v_lshlrev_b32 v118, 16, v247
  v_and_b32 v119, 0xffff0000, v247
  v_lshlrev_b32 v88, 16, v80
  v_and_b32 v89, 0xffff0000, v80
  v_lshlrev_b32 v90, 16, v81
  v_and_b32 v91, 0xffff0000, v81
  v_lshlrev_b32 v92, 16, v82
  v_and_b32 v93, 0xffff0000, v82
  v_lshlrev_b32 v94, 16, v83
  v_and_b32 v95, 0xffff0000, v83
  v_lshlrev_b32 v96, 16, v84
  v_and_b32 v97, 0xffff0000, v84
  v_lshlrev_b32 v98, 16, v85
  v_and_b32 v99, 0xffff0000, v85
  v_lshlrev_b32 v100, 16, v86
  v_and_b32 v101, 0xffff0000, v86
  v_lshlrev_b32 v102, 16, v87
  v_and_b32 v103, 0xffff0000, v87
  v_add_f32 v88, v88, v104
  v_add_f32 v89, v89, v105
  v_add_f32 v90, v90, v106
  v_add_f32 v91, v91, v107
  v_add_f32 v92, v92, v108
  v_add_f32 v93, v93, v109
  v_add_f32 v94, v94, v110
  v_add_f32 v95, v95, v111
  v_add_f32 v96, v96, v112
  v_add_f32 v97, v97, v113
  v_add_f32 v98, v98, v114
  v_add_f32 v99, v99, v115
  v_add_f32 v100, v100, v116
  v_add_f32 v101, v101, v117
  v_add_f32 v102, v102, v118
  v_add_f32 v103, v103, v119
  s_waitcnt vmcnt(10)
  v_mfma_f32_32x32x16_bf16 v[128:143], a[0:3], v[16:19], 0
  buffer_load_dwordx4 v[64:67], v2, s[36:39], s5 offen offset:2048 sc1
  buffer_load_dwordx4 v[68:71], v2, s[36:39], s91 offen offset:2048 sc1
  v_mfma_f32_32x32x16_bf16 v[144:159], a[4:7], v[16:19], 0
  v_mfma_f32_32x32x16_bf16 v[160:175], a[0:3], v[20:23], 0
  v_mfma_f32_32x32x16_bf16 v[176:191], a[4:7], v[20:23], 0
  s_waitcnt vmcnt(10)
  v_mfma_f32_32x32x16_bf16 v[128:143], a[8:11], v[24:27], v[128:143]
  s_add_u32 s82, s87, 1
  s_and_b32 s82, s82, 3
  s_mul_i32 s82, s82, 7168
  s_add_u32 s5, s89, s82
  s_add_u32 s91, s5, 114688
  buffer_load_dwordx4 v[72:75], v2, s[36:39], s5 offen offset:0 sc1
  buffer_load_dwordx4 v[76:79], v2, s[36:39], s91 offen offset:0 sc1
  v_mfma_f32_32x32x16_bf16 v[144:159], a[12:15], v[24:27], v[144:159]
  v_mfma_f32_32x32x16_bf16 v[160:175], a[8:11], v[28:31], v[160:175]
  v_mfma_f32_32x32x16_bf16 v[176:191], a[12:15], v[28:31], v[176:191]
  s_waitcnt vmcnt(10)
  v_mfma_f32_32x32x16_bf16 v[128:143], a[16:19], v[32:35], v[128:143]
  buffer_load_dwordx4 v[16:19], v2, s[36:39], s5 offen offset:1024 sc1
  buffer_load_dwordx4 v[20:23], v2, s[36:39], s91 offen offset:1024 sc1
  v_mfma_f32_32x32x16_bf16 v[144:159], a[20:23], v[32:35], v[144:159]
  v_mfma_f32_32x32x16_bf16 v[160:175], a[16:19], v[36:39], v[160:175]
  v_mfma_f32_32x32x16_bf16 v[176:191], a[20:23], v[36:39], v[176:191]
  s_waitcnt vmcnt(10)
  v_mfma_f32_32x32x16_bf16 v[128:143], a[24:27], v[40:43], v[128:143]
  buffer_load_dwordx4 v[24:27], v2, s[36:39], s5 offen offset:2048 sc1
  buffer_load_dwordx4 v[28:31], v2, s[36:39], s91 offen offset:2048 sc1
  v_mfma_f32_32x32x16_bf16 v[144:159], a[28:31], v[40:43], v[144:159]
  v_mfma_f32_32x32x16_bf16 v[160:175], a[24:27], v[44:47], v[160:175]
  v_mfma_f32_32x32x16_bf16 v[176:191], a[28:31], v[44:47], v[176:191]
  s_waitcnt vmcnt(10)
  v_mfma_f32_32x32x16_bf16 v[128:143], a[32:35], v[48:51], v[128:143]
  buffer_load_dwordx4 v[32:35], v2, s[36:39], s5 offen offset:3072 sc1
  buffer_load_dwordx4 v[36:39], v2, s[36:39], s91 offen offset:3072 sc1
  v_mfma_f32_32x32x16_bf16 v[144:159], a[36:39], v[48:51], v[144:159]
  v_mfma_f32_32x32x16_bf16 v[160:175], a[32:35], v[52:55], v[160:175]
  v_mfma_f32_32x32x16_bf16 v[176:191], a[36:39], v[52:55], v[176:191]
  s_waitcnt vmcnt(10)
  v_mfma_f32_32x32x16_bf16 v[128:143], a[40:43], v[56:59], v[128:143]
  s_add_u32 s5, s5, 4096
  s_add_u32 s91, s91, 4096
  buffer_load_dwordx4 v[40:43], v2, s[36:39], s5 offen offset:0 sc1
  buffer_load_dwordx4 v[44:47], v2, s[36:39], s91 offen offset:0 sc1
  v_mfma_f32_32x32x16_bf16 v[144:159], a[44:47], v[56:59], v[144:159]
  v_mfma_f32_32x32x16_bf16 v[160:175], a[40:43], v[60:63], v[160:175]
  v_mfma_f32_32x32x16_bf16 v[176:191], a[44:47], v[60:63], v[176:191]
  s_waitcnt vmcnt(10)
  v_mfma_f32_32x32x16_bf16 v[128:143], a[48:51], v[64:67], v[128:143]
  buffer_load_dwordx4 v[48:51], v2, s[36:39], s5 offen offset:1024 sc1
  buffer_load_dwordx4 v[52:55], v2, s[36:39], s91 offen offset:1024 sc1
  v_mfma_f32_32x32x16_bf16 v[144:159], a[52:55], v[64:67], v[144:159]
  v_mfma_f32_32x32x16_bf16 v[160:175], a[48:51], v[68:71], v[160:175]
  v_mfma_f32_32x32x16_bf16 v[176:191], a[52:55], v[68:71], v[176:191]
  s_waitcnt vmcnt(10)
  v_mfma_f32_32x32x16_bf16 v[128:143], a[56:59], v[72:75], v[128:143]
  buffer_load_dwordx4 v[56:59], v2, s[36:39], s5 offen offset:2048 sc1
  buffer_load_dwordx4 v[60:63], v2, s[36:39], s91 offen offset:2048 sc1
  v_mfma_f32_32x32x16_bf16 v[144:159], a[60:63], v[72:75], v[144:159]
  v_mfma_f32_32x32x16_bf16 v[160:175], a[56:59], v[76:79], v[160:175]
  v_mfma_f32_32x32x16_bf16 v[176:191], a[60:63], v[76:79], v[176:191]
  s_waitcnt vmcnt(10)
  v_mfma_f32_32x32x16_bf16 v[128:143], a[64:67], v[16:19], v[128:143]
  s_add_u32 s82, s87, 2
  s_and_b32 s82, s82, 3
  s_mul_i32 s82, s82, 7168
  s_add_u32 s5, s89, s82
  s_add_u32 s91, s5, 114688
  buffer_load_dwordx4 v[64:67], v2, s[36:39], s5 offen offset:0 sc1
  buffer_load_dwordx4 v[68:71], v2, s[36:39], s91 offen offset:0 sc1
  v_mfma_f32_32x32x16_bf16 v[144:159], a[68:71], v[16:19], v[144:159]
  v_mfma_f32_32x32x16_bf16 v[160:175], a[64:67], v[20:23], v[160:175]
  v_mfma_f32_32x32x16_bf16 v[176:191], a[68:71], v[20:23], v[176:191]
  s_waitcnt vmcnt(10)
  v_mfma_f32_32x32x16_bf16 v[128:143], a[72:75], v[24:27], v[128:143]
  buffer_load_dwordx4 v[72:75], v2, s[36:39], s5 offen offset:1024 sc1
  buffer_load_dwordx4 v[76:79], v2, s[36:39], s91 offen offset:1024 sc1
  v_mfma_f32_32x32x16_bf16 v[144:159], a[76:79], v[24:27], v[144:159]
  v_mfma_f32_32x32x16_bf16 v[160:175], a[72:75], v[28:31], v[160:175]
  v_mfma_f32_32x32x16_bf16 v[176:191], a[76:79], v[28:31], v[176:191]
  s_waitcnt vmcnt(10)
  v_mfma_f32_32x32x16_bf16 v[128:143], a[80:83], v[32:35], v[128:143]
  buffer_load_dwordx4 v[16:19], v2, s[36:39], s5 offen offset:2048 sc1
  buffer_load_dwordx4 v[20:23], v2, s[36:39], s91 offen offset:2048 sc1
  v_mfma_f32_32x32x16_bf16 v[144:159], a[84:87], v[32:35], v[144:159]
  v_mfma_f32_32x32x16_bf16 v[160:175], a[80:83], v[36:39], v[160:175]
  v_mfma_f32_32x32x16_bf16 v[176:191], a[84:87], v[36:39], v[176:191]
  s_waitcnt vmcnt(10)
  v_mfma_f32_32x32x16_bf16 v[128:143], a[88:91], v[40:43], v[128:143]
  buffer_load_dwordx4 v[24:27], v2, s[36:39], s5 offen offset:3072 sc1
  buffer_load_dwordx4 v[28:31], v2, s[36:39], s91 offen offset:3072 sc1
  v_mfma_f32_32x32x16_bf16 v[144:159], a[92:95], v[40:43], v[144:159]
  v_mfma_f32_32x32x16_bf16 v[160:175], a[88:91], v[44:47], v[160:175]
  v_mfma_f32_32x32x16_bf16 v[176:191], a[92:95], v[44:47], v[176:191]
  s_waitcnt vmcnt(10)
  v_mfma_f32_32x32x16_bf16 v[128:143], a[96:99], v[48:51], v[128:143]
  s_add_u32 s5, s5, 4096
  s_add_u32 s91, s91, 4096
  buffer_load_dwordx4 v[32:35], v2, s[36:39], s5 offen offset:0 sc1
  buffer_load_dwordx4 v[36:39], v2, s[36:39], s91 offen offset:0 sc1
  v_mfma_f32_32x32x16_bf16 v[144:159], a[100:103], v[48:51], v[144:159]
  v_mfma_f32_32x32x16_bf16 v[160:175], a[96:99], v[52:55], v[160:175]
  v_mfma_f32_32x32x16_bf16 v[176:191], a[100:103], v[52:55], v[176:191]
  s_waitcnt vmcnt(10)
  v_mfma_f32_32x32x16_bf16 v[128:143], a[104:107], v[56:59], v[128:143]
  buffer_load_dwordx4 v[40:43], v2, s[36:39], s5 offen offset:1024 sc1
  buffer_load_dwordx4 v[44:47], v2, s[36:39], s91 offen offset:1024 sc1
  v_mfma_f32_32x32x16_bf16 v[144:159], a[108:111], v[56:59], v[144:159]
  v_mfma_f32_32x32x16_bf16 v[160:175], a[104:107], v[60:63], v[160:175]
  v_mfma_f32_32x32x16_bf16 v[176:191], a[108:111], v[60:63], v[176:191]
  s_waitcnt vmcnt(10)
  v_mfma_f32_32x32x16_bf16 v[128:143], a[112:115], v[64:67], v[128:143]
  buffer_load_dwordx4 v[48:51], v2, s[36:39], s5 offen offset:2048 sc1
  buffer_load_dwordx4 v[52:55], v2, s[36:39], s91 offen offset:2048 sc1
  v_mfma_f32_32x32x16_bf16 v[144:159], a[116:119], v[64:67], v[144:159]
  v_mfma_f32_32x32x16_bf16 v[160:175], a[112:115], v[68:71], v[160:175]
  v_mfma_f32_32x32x16_bf16 v[176:191], a[116:119], v[68:71], v[176:191]
  s_waitcnt vmcnt(10)
  v_mfma_f32_32x32x16_bf16 v[128:143], a[120:123], v[72:75], v[128:143]
  s_add_u32 s82, s87, 3
  s_and_b32 s82, s82, 3
  s_mul_i32 s82, s82, 7168
  s_add_u32 s5, s89, s82
  s_add_u32 s91, s5, 114688
  buffer_load_dwordx4 v[56:59], v2, s[36:39], s5 offen offset:0 sc1
  buffer_load_dwordx4 v[60:63], v2, s[36:39], s91 offen offset:0 sc1
  v_mfma_f32_32x32x16_bf16 v[144:159], a[124:127], v[72:75], v[144:159]
  v_mfma_f32_32x32x16_bf16 v[160:175], a[120:123], v[76:79], v[160:175]
  v_mfma_f32_32x32x16_bf16 v[176:191], a[124:127], v[76:79], v[176:191]
  s_waitcnt vmcnt(10)
  v_mfma_f32_32x32x16_bf16 v[128:143], a[128:131], v[16:19], v[128:143]
  buffer_load_dwordx4 v[64:67], v2, s[36:39], s5 offen offset:1024 sc1
  buffer_load_dwordx4 v[68:71], v2, s[36:39], s91 offen offset:1024 sc1
  v_mfma_f32_32x32x16_bf16 v[144:159], a[132:135], v[16:19], v[144:159]
  v_mfma_f32_32x32x16_bf16 v[160:175], a[128:131], v[20:23], v[160:175]
  v_mfma_f32_32x32x16_bf16 v[176:191], a[132:135], v[20:23], v[176:191]
  s_waitcnt vmcnt(10)
  v_mfma_f32_32x32x16_bf16 v[128:143], a[136:139], v[24:27], v[128:143]
  buffer_load_dwordx4 v[72:75], v2, s[36:39], s5 offen offset:2048 sc1
  buffer_load_dwordx4 v[76:79], v2, s[36:39], s91 offen offset:2048 sc1
  v_mfma_f32_32x32x16_bf16 v[144:159], a[140:143], v[24:27], v[144:159]
  v_mfma_f32_32x32x16_bf16 v[160:175], a[136:139], v[28:31], v[160:175]
  v_mfma_f32_32x32x16_bf16 v[176:191], a[140:143], v[28:31], v[176:191]
  s_waitcnt vmcnt(10)
  v_mfma_f32_32x32x16_bf16 v[128:143], a[144:147], v[32:35], v[128:143]
  buffer_load_dwordx4 v[16:19], v2, s[36:39], s5 offen offset:3072 sc1
  buffer_load_dwordx4 v[20:23], v2, s[36:39], s91 offen offset:3072 sc1
  v_mfma_f32_32x32x16_bf16 v[144:159], a[148:151], v[32:35], v[144:159]
  v_mfma_f32_32x32x16_bf16 v[160:175], a[144:147], v[36:39], v[160:175]
  v_mfma_f32_32x32x16_bf16 v[176:191], a[148:151], v[36:39], v[176:191]
  s_waitcnt vmcnt(10)
  v_mfma_f32_32x32x16_bf16 v[128:143], a[152:155], v[40:43], v[128:143]
  s_add_u32 s5, s5, 4096
  s_add_u32 s91, s91, 4096
  buffer_load_dwordx4 v[24:27], v2, s[36:39], s5 offen offset:0 sc1
  buffer_load_dwordx4 v[28:31], v2, s[36:39], s91 offen offset:0 sc1
  v_mfma_f32_32x32x16_bf16 v[144:159], a[156:159], v[40:43], v[144:159]
  v_mfma_f32_32x32x16_bf16 v[160:175], a[152:155], v[44:47], v[160:175]
  v_mfma_f32_32x32x16_bf16 v[176:191], a[156:159], v[44:47], v[176:191]
  s_waitcnt vmcnt(10)
  v_mfma_f32_32x32x16_bf16 v[128:143], a[160:163], v[48:51], v[128:143]
  buffer_load_dwordx4 v[32:35], v2, s[36:39], s5 offen offset:1024 sc1
  buffer_load_dwordx4 v[36:39], v2, s[36:39], s91 offen offset:1024 sc1
  v_mfma_f32_32x32x16_bf16 v[144:159], a[164:167], v[48:51], v[144:159]
  v_mfma_f32_32x32x16_bf16 v[160:175], a[160:163], v[52:55], v[160:175]
  v_mfma_f32_32x32x16_bf16 v[176:191], a[164:167], v[52:55], v[176:191]
  s_waitcnt vmcnt(10)
  v_mfma_f32_32x32x16_bf16 v[128:143], a[168:171], v[56:59], v[128:143]
  buffer_load_dwordx4 v[40:43], v2, s[36:39], s5 offen offset:2048 sc1
  buffer_load_dwordx4 v[44:47], v2, s[36:39], s91 offen offset:2048 sc1
  v_mfma_f32_32x32x16_bf16 v[144:159], a[172:175], v[56:59], v[144:159]
  v_mfma_f32_32x32x16_bf16 v[160:175], a[168:171], v[60:63], v[160:175]
  v_mfma_f32_32x32x16_bf16 v[176:191], a[172:175], v[60:63], v[176:191]
  s_waitcnt vmcnt(10)
  v_mfma_f32_32x32x16_bf16 v[128:143], a[176:179], v[64:67], v[128:143]
  v_mfma_f32_32x32x16_bf16 v[144:159], a[180:183], v[64:67], v[144:159]
  v_mfma_f32_32x32x16_bf16 v[160:175], a[176:179], v[68:71], v[160:175]
  v_mfma_f32_32x32x16_bf16 v[176:191], a[180:183], v[68:71], v[176:191]
  s_waitcnt vmcnt(8)
  v_mfma_f32_32x32x16_bf16 v[128:143], a[184:187], v[72:75], v[128:143]
  v_mfma_f32_32x32x16_bf16 v[144:159], a[188:191], v[72:75], v[144:159]
  v_mfma_f32_32x32x16_bf16 v[160:175], a[184:187], v[76:79], v[160:175]
  v_mfma_f32_32x32x16_bf16 v[176:191], a[188:191], v[76:79], v[176:191]
  s_waitcnt vmcnt(6)
  v_mfma_f32_32x32x16_bf16 v[128:143], a[192:195], v[16:19], v[128:143]
  v_mfma_f32_32x32x16_bf16 v[144:159], a[196:199], v[16:19], v[144:159]
  v_mfma_f32_32x32x16_bf16 v[160:175], a[192:195], v[20:23], v[160:175]
  v_mfma_f32_32x32x16_bf16 v[176:191], a[196:199], v[20:23], v[176:191]
  s_waitcnt vmcnt(4)
  v_mfma_f32_32x32x16_bf16 v[128:143], a[200:203], v[24:27], v[128:143]
  v_mfma_f32_32x32x16_bf16 v[144:159], a[204:207], v[24:27], v[144:159]
  v_mfma_f32_32x32x16_bf16 v[160:175], a[200:203], v[28:31], v[160:175]
  v_mfma_f32_32x32x16_bf16 v[176:191], a[204:207], v[28:31], v[176:191]
  s_waitcnt vmcnt(2)
  v_mfma_f32_32x32x16_bf16 v[128:143], a[208:211], v[32:35], v[128:143]
  v_mfma_f32_32x32x16_bf16 v[144:159], a[212:215], v[32:35], v[144:159]
  v_mfma_f32_32x32x16_bf16 v[160:175], a[208:211], v[36:39], v[160:175]
  v_mfma_f32_32x32x16_bf16 v[176:191], a[212:215], v[36:39], v[176:191]
  s_waitcnt vmcnt(0)
  v_mfma_f32_32x32x16_bf16 v[128:143], a[216:219], v[40:43], v[128:143]
  v_mfma_f32_32x32x16_bf16 v[144:159], a[220:223], v[40:43], v[144:159]
  v_mfma_f32_32x32x16_bf16 v[160:175], a[216:219], v[44:47], v[160:175]
  v_mfma_f32_32x32x16_bf16 v[176:191], a[220:223], v[44:47], v[176:191]
  v_add_u32 v249, 114688, v2
  s_nop 11
  s_cmp_lg_u32 s78, 0
  s_cbranch_scc1 L_rw_32
  ds_write_b128 v249, v[144:147] offset:20480
  ds_write_b128 v249, v[148:151] offset:21504
  ds_write_b128 v249, v[152:155] offset:22528
  ds_write_b128 v249, v[156:159] offset:23552
  ds_write_b128 v249, v[160:163] offset:28672
  ds_write_b128 v249, v[164:167] offset:29696
  ds_write_b128 v249, v[168:171] offset:30720
  ds_write_b128 v249, v[172:175] offset:31744
  ds_write_b128 v249, v[176:179] offset:36864
  ds_write_b128 v249, v[180:183] offset:37888
  ds_write_b128 v249, v[184:187] offset:38912
  ds_write_b128 v249, v[188:191] offset:39936
  s_branch L_rw_31
L_rw_32:
  s_cmp_lg_u32 s78, 1
  s_cbranch_scc1 L_rw_33
  ds_write_b128 v249, v[128:131] offset:0
  ds_write_b128 v249, v[132:135] offset:1024
  ds_write_b128 v249, v[136:139] offset:2048
  ds_write_b128 v249, v[140:143] offset:3072
  ds_write_b128 v249, v[160:163] offset:32768
  ds_write_b128 v249, v[164:167] offset:33792
  ds_write_b128 v249, v[168:171] offset:34816
  ds_write_b128 v249, v[172:175] offset:35840
  ds_write_b128 v249, v[176:179] offset:40960
  ds_write_b128 v249, v[180:183] offset:41984
  ds_write_b128 v249, v[184:187] offset:43008
  ds_write_b128 v249, v[188:191] offset:44032
  v_pk_mov_b32 v[128:129], v[144:145], v[144:145] op_sel:[0,1]
  v_pk_mov_b32 v[130:131], v[146:147], v[146:147] op_sel:[0,1]
  v_pk_mov_b32 v[132:133], v[148:149], v[148:149] op_sel:[0,1]
  v_pk_mov_b32 v[134:135], v[150:151], v[150:151] op_sel:[0,1]
  v_pk_mov_b32 v[136:137], v[152:153], v[152:153] op_sel:[0,1]
  v_pk_mov_b32 v[138:139], v[154:155], v[154:155] op_sel:[0,1]
  v_pk_mov_b32 v[140:141], v[156:157], v[156:157] op_sel:[0,1]
  v_pk_mov_b32 v[142:143], v[158:159], v[158:159] op_sel:[0,1]
  s_branch L_rw_31
L_rw_33:
  s_cmp_lg_u32 s78, 2
  s_cbranch_scc1 L_rw_34
  ds_write_b128 v249, v[128:131] offset:4096
  ds_write_b128 v249, v[132:135] offset:5120
  ds_write_b128 v249, v[136:139] offset:6144
  ds_write_b128 v249, v[140:143] offset:7168
  ds_write_b128 v249, v[144:147] offset:12288
  ds_write_b128 v249, v[148:151] offset:13312
  ds_write_b128 v249, v[152:155] offset:14336
  ds_write_b128 v249, v[156:159] offset:15360
  ds_write_b128 v249, v[176:179] offset:45056
  ds_write_b128 v249, v[180:183] offset:46080
  ds_write_b128 v249, v[184:187] offset:47104
  ds_write_b128 v249, v[188:191] offset:48128
  v_pk_mov_b32 v[128:129], v[160:161], v[160:161] op_sel:[0,1]
  v_pk_mov_b32 v[130:131], v[162:163], v[162:163] op_sel:[0,1]
  v_pk_mov_b32 v[132:133], v[164:165], v[164:165] op_sel:[0,1]
  v_pk_mov_b32 v[134:135], v[166:167], v[166:167] op_sel:[0,1]
  v_pk_mov_b32 v[136:137], v[168:169], v[168:169] op_sel:[0,1]
  v_pk_mov_b32 v[138:139], v[170:171], v[170:171] op_sel:[0,1]
  v_pk_mov_b32 v[140:141], v[172:173], v[172:173] op_sel:[0,1]
  v_pk_mov_b32 v[142:143], v[174:175], v[174:175] op_sel:[0,1]
  s_branch L_rw_31
L_rw_34:
  ds_write_b128 v249, v[128:131] offset:8192
  ds_write_b128 v249, v[132:135] offset:9216
  ds_write_b128 v249, v[136:139] offset:10240
  ds_write_b128 v249, v[140:143] offset:11264
  ds_write_b128 v249, v[144:147] offset:16384
  ds_write_b128 v249, v[148:151] offset:17408
  ds_write_b128 v249, v[152:155] offset:18432
  ds_write_b128 v249, v[156:159] offset:19456
  ds_write_b128 v249, v[160:163] offset:24576
  ds_write_b128 v249, v[164:167] offset:25600
  ds_write_b128 v249, v[168:171] offset:26624
  ds_write_b128 v249, v[172:175] offset:27648
  v_pk_mov_b32 v[128:129], v[176:177], v[176:177] op_sel:[0,1]
  v_pk_mov_b32 v[130:131], v[178:179], v[178:179] op_sel:[0,1]
  v_pk_mov_b32 v[132:133], v[180:181], v[180:181] op_sel:[0,1]
  v_pk_mov_b32 v[134:135], v[182:183], v[182:183] op_sel:[0,1]
  v_pk_mov_b32 v[136:137], v[184:185], v[184:185] op_sel:[0,1]
  v_pk_mov_b32 v[138:139], v[186:187], v[186:187] op_sel:[0,1]
  v_pk_mov_b32 v[140:141], v[188:189], v[188:189] op_sel:[0,1]
  v_pk_mov_b32 v[142:143], v[190:191], v[190:191] op_sel:[0,1]
L_rw_31:
  s_waitcnt lgkmcnt(0)
  s_barrier
  s_mul_i32 s82, s78, 12288
  v_add_u32 v7, s82, v249
  ds_read_b128 v[144:147], v7 offset:0
  ds_read_b128 v[148:151], v7 offset:1024
  ds_read_b128 v[152:155], v7 offset:2048
  ds_read_b128 v[156:159], v7 offset:3072
  ds_read_b128 v[160:163], v7 offset:4096
  ds_read_b128 v[164:167], v7 offset:5120
  ds_read_b128 v[168:171], v7 offset:6144
  ds_read_b128 v[172:175], v7 offset:7168
  ds_read_b128 v[176:179], v7 offset:8192
  ds_read_b128 v[180:183], v7 offset:9216
  ds_read_b128 v[184:187], v7 offset:10240
  ds_read_b128 v[188:191], v7 offset:11264
  s_waitcnt lgkmcnt(8)
  v_pk_add_f32 v[128:129], v[128:129], v[144:145]
  v_pk_add_f32 v[130:131], v[130:131], v[146:147]
  v_pk_add_f32 v[132:133], v[132:133], v[148:149]
  v_pk_add_f32 v[134:135], v[134:135], v[150:151]
  v_pk_add_f32 v[136:137], v[136:137], v[152:153]
  v_pk_add_f32 v[138:139], v[138:139], v[154:155]
  v_pk_add_f32 v[140:141], v[140:141], v[156:157]
  v_pk_add_f32 v[142:143], v[142:143], v[158:159]
  s_waitcnt lgkmcnt(4)
  v_pk_add_f32 v[128:129], v[128:129], v[160:161]
  v_pk_add_f32 v[130:131], v[130:131], v[162:163]
  v_pk_add_f32 v[132:133], v[132:133], v[164:165]
  v_pk_add_f32 v[134:135], v[134:135], v[166:167]
  v_pk_add_f32 v[136:137], v[136:137], v[168:169]
  v_pk_add_f32 v[138:139], v[138:139], v[170:171]
  v_pk_add_f32 v[140:141], v[140:141], v[172:173]
  v_pk_add_f32 v[142:143], v[142:143], v[174:175]
  s_waitcnt lgkmcnt(0)
  v_pk_add_f32 v[128:129], v[128:129], v[176:177]
  v_pk_add_f32 v[130:131], v[130:131], v[178:179]
  v_pk_add_f32 v[132:133], v[132:133], v[180:181]
  v_pk_add_f32 v[134:135], v[134:135], v[182:183]
  v_pk_add_f32 v[136:137], v[136:137], v[184:185]
  v_pk_add_f32 v[138:139], v[138:139], v[186:187]
  v_pk_add_f32 v[140:141], v[140:141], v[188:189]
  v_pk_add_f32 v[142:143], v[142:143], v[190:191]
  v_pk_add_f32 v[128:129], v[128:129], v[88:89]
  v_pk_add_f32 v[130:131], v[130:131], v[90:91]
  v_pk_add_f32 v[132:133], v[132:133], v[92:93]
  v_pk_add_f32 v[134:135], v[134:135], v[94:95]
  v_pk_add_f32 v[136:137], v[136:137], v[96:97]
  v_pk_add_f32 v[138:139], v[138:139], v[98:99]
  v_pk_add_f32 v[140:141], v[140:141], v[100:101]
  v_pk_add_f32 v[142:143], v[142:143], v[102:103]
  v_cvt_pk_bf16_f32 v144, v128, v129
  v_cvt_pk_bf16_f32 v145, v130, v131
  v_cvt_pk_bf16_f32 v146, v132, v133
  v_cvt_pk_bf16_f32 v147, v134, v135
  v_cvt_pk_bf16_f32 v148, v136, v137
  v_cvt_pk_bf16_f32 v149, v138, v139
  v_cvt_pk_bf16_f32 v150, v140, v141
  v_cvt_pk_bf16_f32 v151, v142, v143
  v_permlane32_swap_b32 v144, v146
  v_permlane32_swap_b32 v145, v147
  v_permlane32_swap_b32 v148, v150
  v_permlane32_swap_b32 v149, v151
  buffer_store_dwordx4 v[144:147], v248, s[32:35], s7 offen
  buffer_store_dwordx4 v[148:151], v248, s[32:35], s7 offen offset:32
  s_endpgm
L_IDLE:
  s_cmp_lg_u32 s77, 14
  s_cbranch_scc1 L_tch_36
  s_cmp_ge_u32 s76, 14
  s_cbranch_scc1 L_tch_36
  s_mul_i32 s71, s78, 57344
  s_lshl_b32 s82, s76, 8
  s_add_u32 s71, s71, s82
  s_barrier
  s_add_u32 s74, s71, 0
  s_add_u32 m0, s72, 0
  s_add_u32 s81, s74, 0
  buffer_load_dwordx4 v253, s[24:27], s81 offen lds
  s_add_u32 m0, s72, 1024
  s_add_u32 s81, s74, 14336
  buffer_load_dwordx4 v253, s[24:27], s81 offen lds
  s_add_u32 m0, s72, 2048
  s_add_u32 s81, s74, 28672
  buffer_load_dwordx4 v253, s[24:27], s81 offen lds
  s_add_u32 m0, s72, 3072
  s_add_u32 s81, s74, 43008
  buffer_load_dwordx4 v253, s[24:27], s81 offen lds
  s_add_u32 s74, s71, 229376
  s_add_u32 m0, s72, 16384
  s_add_u32 s81, s74, 0
  buffer_load_dwordx4 v253, s[24:27], s81 offen lds
  s_add_u32 m0, s72, 17408
  s_add_u32 s81, s74, 14336
  buffer_load_dwordx4 v253, s[24:27], s81 offen lds
  s_add_u32 m0, s72, 18432
  s_add_u32 s81, s74, 28672
  buffer_load_dwordx4 v253, s[24:27], s81 offen lds
  s_add_u32 m0, s72, 19456
  s_add_u32 s81, s74, 43008
  buffer_load_dwordx4 v253, s[24:27], s81 offen lds
  s_add_u32 s74, s71, 458752
  s_add_u32 m0, s72, 32768
  s_add_u32 s81, s74, 0
  buffer_load_dwordx4 v253, s[24:27], s81 offen lds
  s_add_u32 m0, s72, 33792
  s_add_u32 s81, s74, 14336
  buffer_load_dwordx4 v253, s[24:27], s81 offen lds
  s_add_u32 m0, s72, 34816
  s_add_u32 s81, s74, 28672
  buffer_load_dwordx4 v253, s[24:27], s81 offen lds
  s_add_u32 m0, s72, 35840
  s_add_u32 s81, s74, 43008
  buffer_load_dwordx4 v253, s[24:27], s81 offen lds
  s_add_u32 s74, s71, 688128
  s_add_u32 m0, s72, 49152
  s_add_u32 s81, s74, 0
  buffer_load_dwordx4 v253, s[24:27], s81 offen lds
  s_add_u32 m0, s72, 50176
  s_add_u32 s81, s74, 14336
  buffer_load_dwordx4 v253, s[24:27], s81 offen lds
  s_add_u32 m0, s72, 51200
  s_add_u32 s81, s74, 28672
  buffer_load_dwordx4 v253, s[24:27], s81 offen lds
  s_add_u32 m0, s72, 52224
  s_add_u32 s81, s74, 43008
  buffer_load_dwordx4 v253, s[24:27], s81 offen lds
  s_add_u32 s74, s71, 917504
  s_add_u32 m0, s72, 65536
  s_add_u32 s81, s74, 0
  buffer_load_dwordx4 v253, s[24:27], s81 offen lds
  s_add_u32 m0, s72, 66560
  s_add_u32 s81, s74, 14336
  buffer_load_dwordx4 v253, s[24:27], s81 offen lds
  s_add_u32 m0, s72, 67584
  s_add_u32 s81, s74, 28672
  buffer_load_dwordx4 v253, s[24:27], s81 offen lds
  s_add_u32 m0, s72, 68608
  s_add_u32 s81, s74, 43008
  buffer_load_dwordx4 v253, s[24:27], s81 offen lds
  s_add_u32 s74, s71, 1146880
  s_add_u32 m0, s72, 81920
  s_add_u32 s81, s74, 0
  buffer_load_dwordx4 v253, s[24:27], s81 offen lds
  s_add_u32 m0, s72, 82944
  s_add_u32 s81, s74, 14336
  buffer_load_dwordx4 v253, s[24:27], s81 offen lds
  s_add_u32 m0, s72, 83968
  s_add_u32 s81, s74, 28672
  buffer_load_dwordx4 v253, s[24:27], s81 offen lds
  s_add_u32 m0, s72, 84992
  s_add_u32 s81, s74, 43008
  buffer_load_dwordx4 v253, s[24:27], s81 offen lds
  s_add_u32 s74, s71, 1376256
  s_add_u32 m0, s72, 98304
  s_add_u32 s81, s74, 0
  buffer_load_dwordx4 v253, s[24:27], s81 offen lds
  s_add_u32 m0, s72, 99328
  s_add_u32 s81, s74, 14336
  buffer_load_dwordx4 v253, s[24:27], s81 offen lds
  s_add_u32 m0, s72, 100352
  s_add_u32 s81, s74, 28672
  buffer_load_dwordx4 v253, s[24:27], s81 offen lds
  s_add_u32 m0, s72, 101376
  s_add_u32 s81, s74, 43008
  buffer_load_dwordx4 v253, s[24:27], s81 offen lds
  s_lshl_b32 s82, s76, 2
  s_add_u32 s82, s82, s78
  s_lshl_b32 s89, s82, 6
  v_and_b32 v7, 31, v1
  v_lshlrev_b32 v7, 1, v7
  buffer_load_ushort v10, v7, s[44:47], s89 offen
  v_bfe_u32 v7, v1, 2, 2
  v_lshl_add_u32 v11, v3, 2, v7
  v_lshlrev_b32 v11, 8, v11
  v_bfe_u32 v12, v1, 4, 1
  v_lshl_add_u32 v11, v12, 5, v11
  v_and_b32 v12, 3, v1
  v_lshl_add_u32 v11, v12, 3, v11
  v_xor_b32 v12, 0, v7
  v_lshl_add_u32 v226, v12, 6, v11
  v_add_u32 v230, 0x10000, v226
  v_xor_b32 v12, 1, v7
  v_lshl_add_u32 v227, v12, 6, v11
  v_add_u32 v231, 0x10000, v227
  v_xor_b32 v12, 2, v7
  v_lshl_add_u32 v228, v12, 6, v11
  v_add_u32 v232, 0x10000, v228
  v_xor_b32 v12, 3, v7
  v_lshl_add_u32 v229, v12, 6, v11
  v_add_u32 v233, 0x10000, v229
  v_bfe_u32 v7, v1, 2, 2
  v_xor_b32 v12, s78, v7
  v_and_b32 v11, 0xffffff3f, v226
  v_lshl_or_b32 v8, v12, 6, v11
  v_add_u32 v9, 0x10000, v8
  v_mov_b32 v192, 0x3f803f80
  v_mov_b32 v193, 0x3f803f80
  v_mov_b32 v194, 0x3f803f80
  v_mov_b32 v195, 0x3f803f80
  s_waitcnt vmcnt(0)
  s_barrier
  ds_read_b64_tr_b16 v[16:17], v8 offset:0
  ds_read_b64_tr_b16 v[18:19], v8 offset:2048
  ds_read_b64_tr_b16 v[20:21], v8 offset:4096
  ds_read_b64_tr_b16 v[22:23], v8 offset:6144
  ds_read_b64_tr_b16 v[24:25], v8 offset:8192
  ds_read_b64_tr_b16 v[26:27], v8 offset:10240
  ds_read_b64_tr_b16 v[28:29], v8 offset:12288
  ds_read_b64_tr_b16 v[30:31], v8 offset:14336
  ds_read_b64_tr_b16 v[32:33], v8 offset:16384
  ds_read_b64_tr_b16 v[34:35], v8 offset:18432
  s_waitcnt lgkmcnt(8)
  v_mfma_f32_32x32x16_bf16 v[128:143], v[192:195], v[16:19], 0
  ds_read_b64_tr_b16 v[36:37], v8 offset:20480
  ds_read_b64_tr_b16 v[38:39], v8 offset:22528
  s_waitcnt lgkmcnt(8)
  v_mfma_f32_32x32x16_bf16 v[128:143], v[192:195], v[20:23], v[128:143]
  ds_read_b64_tr_b16 v[16:17], v8 offset:24576
  ds_read_b64_tr_b16 v[18:19], v8 offset:26624
  s_waitcnt lgkmcnt(8)
  v_mfma_f32_32x32x16_bf16 v[128:143], v[192:195], v[24:27], v[128:143]
  ds_read_b64_tr_b16 v[20:21], v8 offset:28672
  ds_read_b64_tr_b16 v[22:23], v8 offset:30720
  s_waitcnt lgkmcnt(8)
  v_mfma_f32_32x32x16_bf16 v[128:143], v[192:195], v[28:31], v[128:143]
  ds_read_b64_tr_b16 v[24:25], v8 offset:32768
  ds_read_b64_tr_b16 v[26:27], v8 offset:34816
  s_waitcnt lgkmcnt(8)
  v_mfma_f32_32x32x16_bf16 v[128:143], v[192:195], v[32:35], v[128:143]
  ds_read_b64_tr_b16 v[28:29], v8 offset:36864
  ds_read_b64_tr_b16 v[30:31], v8 offset:38912
  s_waitcnt lgkmcnt(8)
  v_mfma_f32_32x32x16_bf16 v[128:143], v[192:195], v[36:39], v[128:143]
  ds_read_b64_tr_b16 v[32:33], v8 offset:40960
  ds_read_b64_tr_b16 v[34:35], v8 offset:43008
  s_waitcnt lgkmcnt(8)
  v_mfma_f32_32x32x16_bf16 v[128:143], v[192:195], v[16:19], v[128:143]
  ds_read_b64_tr_b16 v[36:37], v8 offset:45056
  ds_read_b64_tr_b16 v[38:39], v8 offset:47104
  s_waitcnt lgkmcnt(8)
  v_mfma_f32_32x32x16_bf16 v[128:143], v[192:195], v[20:23], v[128:143]
  ds_read_b64_tr_b16 v[16:17], v8 offset:49152
  ds_read_b64_tr_b16 v[18:19], v8 offset:51200
  s_waitcnt lgkmcnt(8)
  v_mfma_f32_32x32x16_bf16 v[128:143], v[192:195], v[24:27], v[128:143]
  ds_read_b64_tr_b16 v[20:21], v8 offset:53248
  ds_read_b64_tr_b16 v[22:23], v8 offset:55296
  s_waitcnt lgkmcnt(8)
  v_mfma_f32_32x32x16_bf16 v[128:143], v[192:195], v[28:31], v[128:143]
  ds_read_b64_tr_b16 v[24:25], v8 offset:57344
  ds_read_b64_tr_b16 v[26:27], v8 offset:59392
  s_waitcnt lgkmcnt(8)
  v_mfma_f32_32x32x16_bf16 v[128:143], v[192:195], v[32:35], v[128:143]
  ds_read_b64_tr_b16 v[28:29], v8 offset:61440
  ds_read_b64_tr_b16 v[30:31], v8 offset:63488
  s_waitcnt lgkmcnt(8)
  v_mfma_f32_32x32x16_bf16 v[128:143], v[192:195], v[36:39], v[128:143]
  ds_read_b64_tr_b16 v[32:33], v9 offset:0
  ds_read_b64_tr_b16 v[34:35], v9 offset:2048
  s_waitcnt lgkmcnt(8)
  v_mfma_f32_32x32x16_bf16 v[128:143], v[192:195], v[16:19], v[128:143]
  ds_read_b64_tr_b16 v[36:37], v9 offset:4096
  ds_read_b64_tr_b16 v[38:39], v9 offset:6144
  s_waitcnt lgkmcnt(8)
  v_mfma_f32_32x32x16_bf16 v[128:143], v[192:195], v[20:23], v[128:143]
  ds_read_b64_tr_b16 v[16:17], v9 offset:8192
  ds_read_b64_tr_b16 v[18:19], v9 offset:10240
  s_waitcnt lgkmcnt(8)
  v_mfma_f32_32x32x16_bf16 v[128:143], v[192:195], v[24:27], v[128:143]
  ds_read_b64_tr_b16 v[20:21], v9 offset:12288
  ds_read_b64_tr_b16 v[22:23], v9 offset:14336
  s_waitcnt lgkmcnt(8)
  v_mfma_f32_32x32x16_bf16 v[128:143], v[192:195], v[28:31], v[128:143]
  ds_read_b64_tr_b16 v[24:25], v9 offset:16384
  ds_read_b64_tr_b16 v[26:27], v9 offset:18432
  s_waitcnt lgkmcnt(8)
  v_mfma_f32_32x32x16_bf16 v[128:143], v[192:195], v[32:35], v[128:143]
  ds_read_b64_tr_b16 v[28:29], v9 offset:20480
  ds_read_b64_tr_b16 v[30:31], v9 offset:22528
  s_waitcnt lgkmcnt(8)
  v_mfma_f32_32x32x16_bf16 v[128:143], v[192:195], v[36:39], v[128:143]
  ds_read_b64_tr_b16 v[32:33], v9 offset:24576
  ds_read_b64_tr_b16 v[34:35], v9 offset:26624
  s_waitcnt lgkmcnt(8)
  v_mfma_f32_32x32x16_bf16 v[128:143], v[192:195], v[16:19], v[128:143]
  ds_read_b64_tr_b16 v[36:37], v9 offset:28672
  ds_read_b64_tr_b16 v[38:39], v9 offset:30720
  s_waitcnt lgkmcnt(8)
  v_mfma_f32_32x32x16_bf16 v[128:143], v[192:195], v[20:23], v[128:143]
  ds_read_b64_tr_b16 v[16:17], v9 offset:32768
  ds_read_b64_tr_b16 v[18:19], v9 offset:34816
  s_waitcnt lgkmcnt(8)
  v_mfma_f32_32x32x16_bf16 v[128:143], v[192:195], v[24:27], v[128:143]
  ds_read_b64_tr_b16 v[20:21], v9 offset:36864
  ds_read_b64_tr_b16 v[22:23], v9 offset:38912
  s_waitcnt lgkmcnt(8)
  v_mfma_f32_32x32x16_bf16 v[128:143], v[192:195], v[28:31], v[128:143]
  ds_read_b64_tr_b16 v[24:25], v9 offset:40960
  ds_read_b64_tr_b16 v[26:27], v9 offset:43008
  s_waitcnt lgkmcnt(8)
  v_mfma_f32_32x32x16_bf16 v[128:143], v[192:195], v[32:35], v[128:143]
  ds_read_b64_tr_b16 v[28:29], v9 offset:45056
  ds_read_b64_tr_b16 v[30:31], v9 offset:47104
  s_waitcnt lgkmcnt(8)
  v_mfma_f32_32x32x16_bf16 v[128:143], v[192:195], v[36:39], v[128:143]
  s_waitcnt lgkmcnt(6)
  v_mfma_f32_32x32x16_bf16 v[128:143], v[192:195], v[16:19], v[128:143]
  s_waitcnt lgkmcnt(4)
  v_mfma_f32_32x32x16_bf16 v[128:143], v[192:195], v[20:23], v[128:143]
  s_waitcnt lgkmcnt(2)
  v_mfma_f32_32x32x16_bf16 v[128:143], v[192:195], v[24:27], v[128:143]
  s_waitcnt lgkmcnt(0)
  v_mfma_f32_32x32x16_bf16 v[128:143], v[192:195], v[28:31], v[128:143]
  s_nop 11
  v_cvt_pk_bf16_f32 v11, v128, v128
  v_lshlrev_b32 v12, 16, v11
  v_sub_f32 v12, v128, v12
  v_cvt_pk_bf16_f32 v12, v12, v12
  v_and_b32 v11, 0xffff, v11
  v_lshl_or_b32 v16, v12, 16, v11
  v_lshl_or_b32 v17, v10, 16, v11
  v_mov_b32 v18, v10
  v_mov_b32 v19, 0
  v_and_b32 v16, v4, v16
  v_and_b32 v17, v4, v17
  v_and_b32 v18, v4, v18
  s_lshl_b32 s82, s76, 2
  s_add_u32 s82, s82, s78
  s_lshl_b32 s83, s82, 10
  s_add_u32 s83, s83, 1769472
  buffer_store_dwordx4 v[16:19], v2, s[36:39], s83 offen sc1
  s_lshl_b32 s84, s82, 8
  s_add_u32 s84, s84, 1703936
  s_waitcnt vmcnt(0)
  v_mov_b32 v14, s97
  v_mov_b32 v15, s96
  v_mov_b32 v13, 0
  s_mov_b64 s[100:101], exec
  s_mov_b64 exec, 1
  buffer_store_dwordx2 v[14:15], v13, s[36:39], s84 offen sc1
  s_mov_b64 exec, s[100:101]
L_tch_36:
L_END:
  s_endpgm
.section .rodata,"a"
.p2align 6
.amdhsa_kernel sequential_preLN__linear_kernel_hedgehog__dense_activation_gelu__prompt_kernel
  .amdhsa_next_free_vgpr 512
  .amdhsa_next_free_sgpr 102
  .amdhsa_accum_offset 256
  .amdhsa_group_segment_fixed_size 0
  .amdhsa_kernarg_size 96
  .amdhsa_user_sgpr_count 2
  .amdhsa_user_sgpr_kernarg_segment_ptr 1
  .amdhsa_system_sgpr_workgroup_id_x 1
  .amdhsa_float_denorm_mode_32 3
.end_amdhsa_kernel
```
